```python
import torch

def _softmax(x, axis=-1):
    return torch.softmax(x, dim=axis)

def _gelu(x):
    return torch.nn.functional.gelu(x, approximate='tanh')

def _silu(x):
    return torch.nn.functional.silu(x)

def _sigmoid(x):
    return torch.sigmoid(x)

def _layernorm(x, axis=-1, eps=1e-05):
    m = x.mean(dim=axis, keepdim=True)
    v = x.var(dim=axis, keepdim=True, unbiased=False)
    return (x - m) / torch.sqrt(v + eps)

def _scatter_add(tgt, idx, src, axis=0):
    return tgt.clone().index_add_(axis, idx, src)

def _segment_sum(src, seg, n):
    out = torch.zeros((n,) + src.shape[1:], dtype=src.dtype)
    return out.index_add_(0, seg, src)

def _pad(x, pw):
    flat = tuple((v for pair in reversed(pw) for v in pair))
    return torch.nn.functional.pad(x, flat)
kernel_name = 'adaLN_cond__gqa_block_cached__dense_activation_silu__decode'

def setup_inputs():

    _w = lambda a: (lambda t: t.to(torch.bfloat16) if t.is_floating_point() else t)(torch.as_tensor(a))

    def _A_setup():
        B, Sq, D = (2, 1, 512)
        Hq, Hkv, Sk, Dh = (32, 8, 32768, 128)
        assert Hq % Hkv == 0, (Hq, Hkv)
        return {'x': _w((lambda *s: torch.randn(*s, dtype=torch.bfloat16) * 0.1)(B, Sq, D)), 'k_cache': _w((lambda *s: torch.randn(*s, dtype=torch.bfloat16) * 0.8)(B, Hkv, Sk, Dh)), 'v_cache': _w((lambda *s: torch.randn(*s, dtype=torch.bfloat16) * 3.2)(B, Hkv, Sk, Dh)), 'wq': _w((lambda *s: torch.randn(*s, dtype=torch.bfloat16) * 0.8)(D, Hq * Dh) * D ** (-0.5)), 'wo': _w((lambda *s: torch.randn(*s, dtype=torch.bfloat16) * 3.2)(Hq * Dh, D) * (Hq * Dh) ** (-0.5))}
    _A_in = _A_setup()

    def _B_setup():
        B, S, D, F = (2, 1, 512, 1792)
        return {'x': _w((lambda *s: torch.randn(*s, dtype=torch.bfloat16) * 0.1)(B, S, D)), 'w1': _w((lambda *s: torch.randn(*s, dtype=torch.bfloat16) * 3.2)(D, F) * D ** (-0.5)), 'w2': _w((lambda *s: torch.randn(*s, dtype=torch.bfloat16) * 3.2)(F, D) * F ** (-0.5))}
    _B_in = _B_setup()
    return {'A_x': _A_in['x'], 'A_k_cache': _A_in['k_cache'], 'A_v_cache': _A_in['v_cache'], 'A_wq': _A_in['wq'], 'A_wo': _A_in['wo'], 'B_x': _B_in['x'], 'B_w1': _B_in['w1'], 'B_w2': _B_in['w2'], 'c': _w((lambda *s: torch.randn(*s, dtype=torch.bfloat16) * 0.4)(2, 512) * 8.0), 'w_mod': _w((lambda *s: torch.randn(*s, dtype=torch.bfloat16) * 0.4)(512, 6 * 512) * 512 ** (-0.5) * 8.0)}

def reference(A_x, A_k_cache, A_v_cache, A_wq, A_wo, B_x, B_w1, B_w2, c, w_mod):

    def _A_ref(x, k_cache, v_cache, wq, wo):
        B, Sq, D = x.shape
        Hq, Dh = (32, 128)
        Hkv = k_cache.shape[1]
        rep = Hq // Hkv
        q = (lambda x, *d: x.permute(*d))((x @ wq).reshape(B, Sq, Hq, Dh), 0, 2, 1, 3)
        k = (lambda x, n, axis: torch.repeat_interleave(x, n, dim=axis))(k_cache, rep, axis=1)
        v = (lambda x, n, axis: torch.repeat_interleave(x, n, dim=axis))(v_cache, rep, axis=1)
        scores = torch.einsum('bhqd,bhkd->bhqk', q, k) * Dh ** (-0.5)
        p = _softmax(scores, axis=-1)
        o = torch.einsum('bhqk,bhkd->bhqd', p, v)
        return (lambda x, *d: x.permute(*d))(o, 0, 2, 1, 3).reshape(B, Sq, Hq * Dh) @ wo

    def _B_ref(x, w1, w2):
        h = torch.einsum('bsd,df->bsf', x, w1)
        h = _silu(h)
        out = torch.einsum('bsf,fd->bsd', h, w2)
        return out
    x = A_x
    mod = (_silu(c) @ w_mod).reshape(c.shape[0], 6, 1, -1)
    sa, ca, ga, sb, cb, gb = (mod[:, 0].clone(), mod[:, 1].clone(), mod[:, 2].clone(), mod[:, 3].clone(), mod[:, 4].clone(), mod[:, 5].clone())
    h = _layernorm(x, axis=-1) * (1 + ca) + sa
    x = x + ga * _A_ref(h, A_k_cache, A_v_cache, A_wq, A_wo)
    h = _layernorm(x, axis=-1) * (1 + cb) + sb
    x = x + gb * _B_ref(h, B_w1, B_w2)
    return x
```

```asm
; @launch grid=(256,1,1) block=(512,1,1) lds=138752
.amdgcn_target "amdgcn-amd-amdhsa--gfx950"
.text
.globl adaLN_cond__gqa_block_cached__dense_activation_silu__decode_kernel
.p2align 8
.type adaLN_cond__gqa_block_cached__dense_activation_silu__decode_kernel,@function
adaLN_cond__gqa_block_cached__dense_activation_silu__decode_kernel:
  s_cmp_ge_u32 s2, 256
  s_cbranch_scc1 L_END
  s_load_dwordx16 s[4:19], s[0:1], 0
  s_load_dwordx8 s[20:27], s[0:1], 64
  s_load_dwordx2 s[28:29], s[0:1], 96
  s_add_u32 s2, s2, 160
  s_and_b32 s2, s2, 255
  v_and_b32 v1, 63, v0
  v_lshrrev_b32 v4, 6, v0
  v_and_b32 v5, 15, v1
  v_lshrrev_b32 v6, 4, v1
  v_readfirstlane_b32 s3, v4
  v_lshlrev_b32 v2, 6, v5
  v_lshl_add_u32 v2, v6, 4, v2
  v_lshlrev_b32 v3, 4, v1
  v_mov_b32 v15, 0
  s_and_b32 s30, s2, 7
  s_lshr_b32 s31, s2, 3
  s_lshr_b32 s56, s2, 5
  s_add_u32 s76, s56, s30
  s_and_b32 s76, s76, 7
  s_bfe_u32 s57, s2, 0x10004
  s_lshl_b32 s57, s57, 3
  s_add_u32 s76, s76, s57
  s_lshl_b32 s77, s56, 1
  s_and_b32 s57, s31, 1
  s_add_u32 s77, s77, s57
  s_lshl_b32 s57, s76, 23
  s_lshl_b32 s74, s76, 8
  s_add_u32 s74, s74, 77824
  s_lshl_b32 s56, s77, 3
  s_add_u32 s72, s56, s3
  s_add_u32 s73, s72, 128
  s_mul_i32 s95, s76, 8
  s_add_u32 s75, s72, s95
  s_and_b32 s75, s75, 1023
  s_lshr_b32 s60, s75, 6
  s_lshl_b32 s60, s60, 3
  s_and_b32 s61, s75, 7
  s_or_b32 s60, s60, s61
  s_and_b32 s61, s60, 7
  s_lshr_b32 s60, s60, 3
  s_lshl_b32 s60, s60, 4
  s_or_b32 s60, s60, s61
  s_bfe_u32 s61, s75, 196611
  s_lshl_b32 s61, s61, 8
  s_or_b32 s60, s60, s61
  s_lshl_b32 s60, s60, 12
  s_cmp_lt_u32 s72, 1024
  s_cselect_b32 s60, s60, 8388608
  s_add_u32 s61, s60, 32768
  s_mov_b32 s34, 8388608
  s_mov_b32 s35, 0x00020000
  s_mov_b32 s38, 8388608
  s_mov_b32 s39, 0x00020000
  s_mov_b32 s98, 0
  s_waitcnt lgkmcnt(0)
  s_add_u32 s32, s6, s57
  s_addc_u32 s33, s7, 0
  s_add_u32 s36, s8, s57
  s_addc_u32 s37, s9, 0
  s_cmp_ge_u32 s2, 160
  s_cbranch_scc0 L_R0
  buffer_load_dwordx4 v[128:131], v2, s[32:35], s60 offen offset:0 nt
  buffer_load_dwordx4 v[132:135], v2, s[32:35], s60 offen offset:1024 nt
  buffer_load_dwordx4 v[136:139], v2, s[32:35], s60 offen offset:2048 nt
  buffer_load_dwordx4 v[140:143], v2, s[32:35], s60 offen offset:3072 nt
  buffer_load_dwordx4 v[144:147], v2, s[32:35], s61 offen offset:0 nt
  buffer_load_dwordx4 v[148:151], v2, s[32:35], s61 offen offset:1024 nt
  buffer_load_dwordx4 v[152:155], v2, s[32:35], s61 offen offset:2048 nt
  buffer_load_dwordx4 v[156:159], v2, s[32:35], s61 offen offset:3072 nt
  buffer_load_dwordx4 v[160:163], v3, s[36:39], s60 offen offset:0 nt
  buffer_load_dwordx4 v[164:167], v3, s[36:39], s60 offen offset:1024 nt
  buffer_load_dwordx4 v[168:171], v3, s[36:39], s60 offen offset:2048 nt
  buffer_load_dwordx4 v[172:175], v3, s[36:39], s60 offen offset:3072 nt
  buffer_load_dwordx4 v[176:179], v3, s[36:39], s61 offen offset:0 nt
  buffer_load_dwordx4 v[180:183], v3, s[36:39], s61 offen offset:1024 nt
  buffer_load_dwordx4 v[184:187], v3, s[36:39], s61 offen offset:2048 nt
  buffer_load_dwordx4 v[188:191], v3, s[36:39], s61 offen offset:3072 nt
  s_mov_b32 s98, 1
L_R0:
  s_mov_b32 s63, 0x05040100
  s_mov_b32 s64, 0x07060302
  s_mov_b32 s65, 1069066811
  s_mov_b32 s66, 1035273459
  s_mov_b32 s67, 1
  s_mov_b32 s56, s31
  s_cmp_lt_u32 s2, 32
  s_cbranch_scc1 L_R1
  s_mov_b32 s67, 2
  s_sub_u32 s56, s31, 12
L_R1:
  s_lshr_b32 s57, s56, 1
  s_lshl_b32 s57, s57, 4
  s_and_b32 s56, s56, 1
  s_add_u32 s57, s57, s56
  s_lshl_b32 s56, s30, 1
  s_add_u32 s69, s57, s56
  s_sub_u32 s56, s2, 32
  s_cmp_lt_u32 s56, 64
  s_cbranch_scc0 L_R2
  s_mov_b32 s67, 3
  s_mov_b32 s69, s56
L_R2:
  s_cmp_ge_u32 s2, 160
  s_cbranch_scc0 L_R3
  s_mov_b32 s67, 0
L_R3:
  s_mov_b32 s68, 0
  s_and_b32 s71, s31, 1
  s_bfe_u32 s70, s31, 0x30001
  s_cmp_ge_u32 s2, 128
  s_cbranch_scc1 L_R5
  s_mov_b32 s68, 1
  s_lshl_b32 s70, s70, 3
  s_add_u32 s70, s70, s30
  s_cmp_lt_u32 s2, 112
  s_cbranch_scc1 L_R5
  s_mov_b32 s68, 2
  s_lshl_b32 s70, s30, 1
  s_add_u32 s70, s70, s71
L_R5:
  s_lshl_b32 s56, s3, 8
  s_add_u32 s56, s56, 131072
  v_and_b32 v4, 1, v1
  v_lshlrev_b32 v4, 7, v4
  v_lshl_add_u32 v4, v6, 4, v4
  v_add_u32 v120, s56, v4
  s_lshl_b32 s56, s3, 9
  s_add_u32 s56, s56, 133120
  v_lshlrev_b32 v4, 6, v5
  v_lshl_add_u32 v4, v6, 4, v4
  v_add_u32 v121, s56, v4
  s_add_u32 s78, s28, s74
  s_addc_u32 s79, s29, 0
  s_sub_u32 s82, s3, 4
  s_mov_b32 s40, s28
  s_mov_b32 s41, s29
  s_mov_b32 s42, 675840
  s_mov_b32 s43, 0x00020000
  s_mov_b32 s48, s26
  s_mov_b32 s49, s27
  s_mov_b32 s50, 256
  s_mov_b32 s51, 0x00020000
  s_cmp_eq_u32 s67, 0
  s_cbranch_scc1 L_FILL
  s_cmp_eq_u32 s67, 3
  s_cbranch_scc1 L_Q
  s_mov_b32 s52, s20
  s_mov_b32 s53, s21
  s_mov_b32 s54, 2048
  s_mov_b32 s55, 0x00020000
  v_lshrrev_b32 v12, 5, v1
  v_lshlrev_b32 v12, 10, v12
  v_and_b32 v4, 31, v1
  v_lshl_add_u32 v12, v4, 2, v12
  s_lshl_b32 s57, s3, 7
  buffer_load_dword v36, v12, s[52:55], s57 offen
  s_lshl_b32 s59, s69, 6
  s_cmp_eq_u32 s67, 2
  s_cselect_b32 s57, 2048, 0
  s_add_u32 s59, s59, s57
  s_mov_b32 s44, s22
  s_mov_b32 s45, s23
  s_mov_b32 s46, 3145728
  s_mov_b32 s47, 0x00020000
  v_lshrrev_b32 v4, 2, v1
  v_mul_u32_u24 v4, 6144, v4
  v_and_b32 v7, 3, v1
  v_lshl_add_u32 v4, v7, 4, v4
  s_mul_i32 s56, s3, 393216
  s_add_u32 s56, s56, s59
  s_mul_i32 s58, s3, 4096
  s_add_u32 s58, s58, 0
  s_mov_b32 m0, s58
  s_add_u32 s58, s58, 1024
  buffer_load_dwordx4 v4, s[44:47], s56 offen  lds
  s_add_u32 s56, s56, 98304
  s_mov_b32 m0, s58
  s_add_u32 s58, s58, 1024
  buffer_load_dwordx4 v4, s[44:47], s56 offen  lds
  s_add_u32 s56, s56, 98304
  s_mov_b32 m0, s58
  s_add_u32 s58, s58, 1024
  buffer_load_dwordx4 v4, s[44:47], s56 offen  lds
  s_add_u32 s56, s56, 98304
  s_mov_b32 m0, s58
  s_add_u32 s58, s58, 1024
  buffer_load_dwordx4 v4, s[44:47], s56 offen  lds
  s_lshl_b32 s56, s3, 8
  s_add_u32 s56, s56, 131072
  v_lshlrev_b32 v13, 2, v1
  v_add_u32 v13, s56, v13
  v_lshrrev_b32 v12, 2, v5
  v_lshl_add_u32 v12, v6, 3, v12
  v_mul_u32_u24 v12, 64, v12
  v_and_b32 v4, 3, v1
  v_lshl_add_u32 v12, v4, 3, v12
  s_mul_i32 s56, s3, 4096
  s_add_u32 s56, s56, 0
  v_add_u32 v12, s56, v12
  s_waitcnt vmcnt(4)
  v_lshlrev_b32 v38, 16, v36
  v_and_b32 v39, 0xffff0000, v36
  v_mul_f32 v112, s65, v38
  v_mul_f32 v113, s65, v39
  v_max_f32 v112, 3271294976, v112
  v_max_f32 v113, 3271294976, v113
  v_exp_f32 v112, -v112
  v_exp_f32 v113, -v113
  s_nop 0
  v_add_f32 v112, 1.0, v112
  v_add_f32 v113, 1.0, v113
  v_rcp_f32 v114, v112
  v_rcp_f32 v115, v113
  s_nop 0
  v_mul_f32 v116, v38, v114
  v_fma_f32 v38, -v116, v112, v38
  v_fma_f32 v38, v38, v114, v116
  v_mul_f32 v117, v39, v115
  v_fma_f32 v39, -v117, v113, v39
  v_fma_f32 v39, v39, v115, v117
  v_cvt_pk_bf16_f32 v36, v38, v39
  ds_write_b32 v13, v36
  s_cmp_eq_u32 s3, 0
  s_cbranch_scc0 L_M1
  s_cmp_eq_u32 s67, 1
  s_cbranch_scc0 L_M1
  s_mov_b32 s62, 400000
  v_lshlrev_b32 v39, 2, v1
  s_mov_b64 exec, 15
PF_1:
  buffer_load_dword v38, v39, s[48:51], 0 offen offset:128 sc1
  s_waitcnt vmcnt(0)
  v_cmp_eq_u32 vcc, 0, v38
  s_cbranch_vccz PFD_2
  s_sub_u32 s62, s62, 1
  s_cbranch_scc1 PFD_2
  s_sleep 1
  s_branch PF_1
PFD_2:
  s_mov_b64 exec, -1
L_M1:
  s_waitcnt vmcnt(0)
L_M1B:
  ds_read_b64_tr_b16 v[64:65], v12 offset:0
  ds_read_b64_tr_b16 v[66:67], v12 offset:256
  ds_read_b64_tr_b16 v[68:69], v12 offset:32
  ds_read_b64_tr_b16 v[70:71], v12 offset:288
  ds_read_b64_tr_b16 v[72:73], v12 offset:2048
  ds_read_b64_tr_b16 v[74:75], v12 offset:2304
  ds_read_b64_tr_b16 v[76:77], v12 offset:2080
  ds_read_b64_tr_b16 v[78:79], v12 offset:2336
  s_waitcnt lgkmcnt(0)
  ds_read_b128 v[40:43], v120 offset:0
  ds_read_b128 v[44:47], v120 offset:64
  s_waitcnt lgkmcnt(1)
  v_mfma_f32_16x16x32_bf16 v[48:51], v[64:67], v[40:43], 0
  v_mfma_f32_16x16x32_bf16 v[52:55], v[68:71], v[40:43], 0
  s_waitcnt lgkmcnt(0)
  v_mfma_f32_16x16x32_bf16 v[48:51], v[72:75], v[44:47], v[48:51]
  v_mfma_f32_16x16x32_bf16 v[52:55], v[76:79], v[44:47], v[52:55]
  s_mov_b32 exec_lo, 0x00030003
  s_mov_b32 exec_hi, 0x00030003
  s_nop 5
  ds_write_b128 v121, v[48:51] offset:0
  ds_write_b128 v121, v[52:55] offset:128
  s_mov_b64 exec, -1
  s_waitcnt lgkmcnt(0)
  s_barrier
  s_cmp_eq_u32 s3, 0
  s_cbranch_scc1 L_M2
  s_cmp_eq_u32 s67, 1
  s_cbranch_scc0 L_FILL
  s_barrier
  s_branch L_FILL
L_M2:
  v_lshlrev_b32 v12, 3, v1
  v_add_u32 v12, 133120, v12
  ds_read_b64 v[48:49], v12 offset:0
  ds_read_b64 v[50:51], v12 offset:512
  ds_read_b64 v[52:53], v12 offset:1024
  ds_read_b64 v[54:55], v12 offset:1536
  ds_read_b64 v[56:57], v12 offset:2048
  ds_read_b64 v[58:59], v12 offset:2560
  ds_read_b64 v[60:61], v12 offset:3072
  ds_read_b64 v[62:63], v12 offset:3584
  s_waitcnt lgkmcnt(6)
  v_pk_add_f32 v[48:49], v[48:49], v[50:51]
  s_waitcnt lgkmcnt(5)
  v_pk_add_f32 v[48:49], v[48:49], v[52:53]
  s_waitcnt lgkmcnt(4)
  v_pk_add_f32 v[48:49], v[48:49], v[54:55]
  s_waitcnt lgkmcnt(3)
  v_pk_add_f32 v[48:49], v[48:49], v[56:57]
  s_waitcnt lgkmcnt(2)
  v_pk_add_f32 v[48:49], v[48:49], v[58:59]
  s_waitcnt lgkmcnt(1)
  v_pk_add_f32 v[48:49], v[48:49], v[60:61]
  s_waitcnt lgkmcnt(0)
  v_pk_add_f32 v[48:49], v[48:49], v[62:63]
  v_cvt_pk_bf16_f32 v48, v48, v49
  v_bfe_u32 v4, v1, 3, 1
  v_lshlrev_b32 v4, 6, v4
  v_lshl_add_u32 v4, v6, 5, v4
  v_and_b32 v7, 7, v1
  v_lshl_add_u32 v4, v7, 2, v4
  s_lshl_b32 s57, s69, 7
  s_cmp_eq_u32 s67, 1
  s_cbranch_scc1 L_M3
  s_add_u32 s57, s57, 20480
  s_mov_b32 s62, 400000
  v_lshlrev_b32 v37, 2, v1
  s_mov_b64 exec, 16
PF_3:
  buffer_load_dword v36, v37, s[48:51], 0 offen offset:128 sc1
  s_waitcnt vmcnt(0)
  v_cmp_eq_u32 vcc, 0, v36
  s_cbranch_vccz PFD_4
  s_sub_u32 s62, s62, 1
  s_cbranch_scc1 PFD_4
  s_sleep 4
  s_branch PF_3
PFD_4:
  s_mov_b64 exec, -1
L_M3:
  s_mov_b32 exec_hi, 0
  buffer_store_dword v48, v4, s[40:43], s57 offen sc1
  s_mov_b64 exec, -1
  s_cmp_eq_u32 s67, 1
  s_cbranch_scc0 L_FILL
  s_barrier
  s_branch L_FILL
L_Q:
  s_cmp_eq_u32 s3, 0
  s_cbranch_scc0 L_Q0
  s_cmp_lt_u32 s69, 4
  s_cbranch_scc0 L_Q1
  s_mul_i32 s56, s69, 5120
  v_mov_b32 v36, -1
  v_mov_b32 v37, -1
  v_mov_b32 v38, -1
  v_mov_b32 v39, -1
  buffer_store_dwordx4 v[36:39], v3, s[40:43], s56 offen offset:0 sc1
  buffer_store_dwordx4 v[36:39], v3, s[40:43], s56 offen offset:1024 sc1
  buffer_store_dwordx4 v[36:39], v3, s[40:43], s56 offen offset:2048 sc1
  buffer_store_dwordx4 v[36:39], v3, s[40:43], s56 offen offset:3072 sc1
  s_add_u32 s56, s56, 4096
  buffer_store_dwordx4 v[36:39], v3, s[40:43], s56 offen offset:0 sc1
  v_mov_b32 v7, 1
  s_waitcnt vmcnt(0)
  s_mov_b64 exec, 1
  s_lshl_b32 s56, s69, 2
  buffer_store_dword v7, v15, s[48:51], s56 offen offset:128 sc1
  s_mov_b64 exec, -1
  s_branch L_Q1
L_Q0:
  s_cmp_eq_u32 s3, 1
  s_cbranch_scc0 L_Q1
  s_mul_i32 s56, s69, 10240
  s_add_u32 s56, s56, 20480
  v_mov_b32 v36, -1
  v_mov_b32 v37, -1
  v_mov_b32 v38, -1
  v_mov_b32 v39, -1
  buffer_store_dwordx4 v[36:39], v3, s[40:43], s56 offen offset:0 sc1
  buffer_store_dwordx4 v[36:39], v3, s[40:43], s56 offen offset:1024 sc1
  buffer_store_dwordx4 v[36:39], v3, s[40:43], s56 offen offset:2048 sc1
  buffer_store_dwordx4 v[36:39], v3, s[40:43], s56 offen offset:3072 sc1
  s_add_u32 s56, s56, 4096
  buffer_store_dwordx4 v[36:39], v3, s[40:43], s56 offen offset:0 sc1
  buffer_store_dwordx4 v[36:39], v3, s[40:43], s56 offen offset:1024 sc1
  buffer_store_dwordx4 v[36:39], v3, s[40:43], s56 offen offset:2048 sc1
  buffer_store_dwordx4 v[36:39], v3, s[40:43], s56 offen offset:3072 sc1
  s_add_u32 s56, s56, 4096
  buffer_store_dwordx4 v[36:39], v3, s[40:43], s56 offen offset:0 sc1
  buffer_store_dwordx4 v[36:39], v3, s[40:43], s56 offen offset:1024 sc1
  v_mov_b32 v7, 1
  s_waitcnt vmcnt(0)
  s_mov_b64 exec, 1
  buffer_atomic_add v7, v15, s[48:51], 0 offen sc0
  s_waitcnt vmcnt(0)
  v_cmp_eq_u32 vcc, 63, v7
  s_cbranch_vccz L_JAN
  v_mov_b32 v7, 1
  buffer_store_dword v7, v15, s[48:51], 0 offen offset:144 sc1
L_JAN:
  s_mov_b64 exec, -1
L_Q1:
  s_mov_b32 s52, s4
  s_mov_b32 s53, s5
  s_mov_b32 s54, 2048
  s_mov_b32 s55, 0x00020000
  v_lshrrev_b32 v12, 5, v1
  v_lshlrev_b32 v12, 10, v12
  v_and_b32 v4, 31, v1
  v_lshl_add_u32 v12, v4, 2, v12
  s_lshl_b32 s57, s3, 7
  v_lshlrev_b32 v13, 5, v1
  buffer_load_dwordx4 v[40:43], v13, s[52:55], 0 offen
  buffer_load_dwordx4 v[44:47], v13, s[52:55], 0 offen offset:16
  buffer_load_dword v36, v12, s[52:55], s57 offen
  s_lshl_b32 s59, s69, 7
  s_mov_b32 s44, s10
  s_mov_b32 s45, s11
  s_mov_b32 s46, 4194304
  s_mov_b32 s47, 0x00020000
  v_lshrrev_b32 v4, 3, v1
  v_mul_u32_u24 v4, 8192, v4
  v_and_b32 v7, 7, v1
  v_lshl_add_u32 v4, v7, 4, v4
  s_mul_i32 s56, s3, 524288
  s_add_u32 s56, s56, s59
  s_mul_i32 s58, s3, 8192
  s_add_u32 s58, s58, 0
  s_mov_b32 m0, s58
  s_add_u32 s58, s58, 1024
  buffer_load_dwordx4 v4, s[44:47], s56 offen  lds
  s_add_u32 s56, s56, 65536
  s_mov_b32 m0, s58
  s_add_u32 s58, s58, 1024
  buffer_load_dwordx4 v4, s[44:47], s56 offen  lds
  s_add_u32 s56, s56, 65536
  s_mov_b32 m0, s58
  s_add_u32 s58, s58, 1024
  buffer_load_dwordx4 v4, s[44:47], s56 offen  lds
  s_add_u32 s56, s56, 65536
  s_mov_b32 m0, s58
  s_add_u32 s58, s58, 1024
  buffer_load_dwordx4 v4, s[44:47], s56 offen  lds
  s_add_u32 s56, s56, 65536
  s_mov_b32 m0, s58
  s_add_u32 s58, s58, 1024
  buffer_load_dwordx4 v4, s[44:47], s56 offen  lds
  s_add_u32 s56, s56, 65536
  s_mov_b32 m0, s58
  s_add_u32 s58, s58, 1024
  buffer_load_dwordx4 v4, s[44:47], s56 offen  lds
  s_add_u32 s56, s56, 65536
  s_mov_b32 m0, s58
  s_add_u32 s58, s58, 1024
  buffer_load_dwordx4 v4, s[44:47], s56 offen  lds
  s_add_u32 s56, s56, 65536
  s_mov_b32 m0, s58
  s_add_u32 s58, s58, 1024
  buffer_load_dwordx4 v4, s[44:47], s56 offen  lds
  s_waitcnt vmcnt(8)
  v_lshlrev_b32 v48, 16, v40
  v_and_b32 v49, 0xffff0000, v40
  v_lshlrev_b32 v50, 16, v41
  v_and_b32 v51, 0xffff0000, v41
  v_lshlrev_b32 v52, 16, v42
  v_and_b32 v53, 0xffff0000, v42
  v_lshlrev_b32 v54, 16, v43
  v_and_b32 v55, 0xffff0000, v43
  v_lshlrev_b32 v56, 16, v44
  v_and_b32 v57, 0xffff0000, v44
  v_lshlrev_b32 v58, 16, v45
  v_and_b32 v59, 0xffff0000, v45
  v_lshlrev_b32 v60, 16, v46
  v_and_b32 v61, 0xffff0000, v46
  v_lshlrev_b32 v62, 16, v47
  v_and_b32 v63, 0xffff0000, v47
  v_add_f32 v112, v48, v49
  v_add_f32 v112, v112, v50
  v_add_f32 v112, v112, v51
  v_add_f32 v112, v112, v52
  v_add_f32 v112, v112, v53
  v_add_f32 v112, v112, v54
  v_add_f32 v112, v112, v55
  v_add_f32 v112, v112, v56
  v_add_f32 v112, v112, v57
  v_add_f32 v112, v112, v58
  v_add_f32 v112, v112, v59
  v_add_f32 v112, v112, v60
  v_add_f32 v112, v112, v61
  v_add_f32 v112, v112, v62
  v_add_f32 v112, v112, v63
  s_nop 1
  v_add_f32_dpp v112, v112, v112 row_ror:8 row_mask:0xf bank_mask:0xf
  s_nop 1
  v_add_f32_dpp v112, v112, v112 row_ror:4 row_mask:0xf bank_mask:0xf
  s_nop 1
  v_add_f32_dpp v112, v112, v112 row_ror:2 row_mask:0xf bank_mask:0xf
  s_nop 1
  v_add_f32_dpp v112, v112, v112 row_ror:1 row_mask:0xf bank_mask:0xf
  v_mov_b32 v113, v112
  s_nop 1
  v_permlane16_swap_b32 v112, v113
  v_add_f32 v112, v112, v113
  v_mul_f32 v112, 989855744, v112
  v_sub_f32 v114, v48, v112
  v_mul_f32 v113, v114, v114
  v_sub_f32 v114, v49, v112
  v_fmac_f32 v113, v114, v114
  v_sub_f32 v114, v50, v112
  v_fmac_f32 v113, v114, v114
  v_sub_f32 v114, v51, v112
  v_fmac_f32 v113, v114, v114
  v_sub_f32 v114, v52, v112
  v_fmac_f32 v113, v114, v114
  v_sub_f32 v114, v53, v112
  v_fmac_f32 v113, v114, v114
  v_sub_f32 v114, v54, v112
  v_fmac_f32 v113, v114, v114
  v_sub_f32 v114, v55, v112
  v_fmac_f32 v113, v114, v114
  v_sub_f32 v114, v56, v112
  v_fmac_f32 v113, v114, v114
  v_sub_f32 v114, v57, v112
  v_fmac_f32 v113, v114, v114
  v_sub_f32 v114, v58, v112
  v_fmac_f32 v113, v114, v114
  v_sub_f32 v114, v59, v112
  v_fmac_f32 v113, v114, v114
  v_sub_f32 v114, v60, v112
  v_fmac_f32 v113, v114, v114
  v_sub_f32 v114, v61, v112
  v_fmac_f32 v113, v114, v114
  v_sub_f32 v114, v62, v112
  v_fmac_f32 v113, v114, v114
  v_sub_f32 v114, v63, v112
  v_fmac_f32 v113, v114, v114
  s_nop 1
  v_add_f32_dpp v113, v113, v113 row_ror:8 row_mask:0xf bank_mask:0xf
  s_nop 1
  v_add_f32_dpp v113, v113, v113 row_ror:4 row_mask:0xf bank_mask:0xf
  s_nop 1
  v_add_f32_dpp v113, v113, v113 row_ror:2 row_mask:0xf bank_mask:0xf
  s_nop 1
  v_add_f32_dpp v113, v113, v113 row_ror:1 row_mask:0xf bank_mask:0xf
  v_mov_b32 v114, v113
  s_nop 1
  v_permlane16_swap_b32 v113, v114
  v_add_f32 v113, v113, v114
  v_mul_f32 v113, 989855744, v113
  v_lshlrev_b32 v38, 16, v36
  v_and_b32 v39, 0xffff0000, v36
  v_cvt_pk_bf16_f32 v114, v112, v113
  v_lshlrev_b32 v112, 16, v114
  v_and_b32 v113, 0xffff0000, v114
  v_add_f32 v113, 925353388, v113
  v_cvt_pk_bf16_f32 v113, v113, v113
  v_lshlrev_b32 v113, 16, v113
  v_sqrt_f32 v113, v113
  v_sub_f32 v38, v38, v112
  v_sub_f32 v39, v39, v112
  v_cvt_pk_bf16_f32 v113, v113, v113
  v_lshlrev_b32 v113, 16, v113
  v_rcp_f32 v116, v113
  v_cvt_pk_bf16_f32 v114, v38, v39
  v_lshlrev_b32 v38, 16, v114
  v_and_b32 v39, 0xffff0000, v114
  v_mul_f32 v114, v38, v116
  v_fma_f32 v38, -v114, v113, v38
  v_fma_f32 v38, v38, v116, v114
  v_mul_f32 v115, v39, v116
  v_fma_f32 v39, -v115, v113, v39
  v_fma_f32 v39, v39, v116, v115
  v_cvt_pk_bf16_f32 v114, v38, v39
  v_lshlrev_b32 v38, 16, v114
  v_and_b32 v39, 0xffff0000, v114
  s_lshl_b32 s56, s3, 8
  s_add_u32 s56, s56, 131072
  v_lshlrev_b32 v13, 2, v1
  v_add_u32 v13, s56, v13
  v_lshrrev_b32 v12, 2, v5
  v_lshl_add_u32 v12, v6, 3, v12
  v_mul_u32_u24 v12, 128, v12
  v_and_b32 v4, 3, v1
  v_lshl_add_u32 v12, v4, 3, v12
  s_mul_i32 s56, s3, 8192
  s_add_u32 s56, s56, 0
  v_add_u32 v12, s56, v12
  v_and_b32 v7, 1, v6
  v_lshlrev_b32 v7, 7, v7
  v_lshrrev_b32 v4, 5, v1
  v_lshl_add_u32 v7, v4, 6, v7
  v_lshl_add_u32 v7, v5, 2, v7
  s_lshl_b32 s57, s3, 8
  s_waitcnt vmcnt(0)
  ds_read_b64_tr_b16 v[64:65], v12 offset:0
  ds_read_b64_tr_b16 v[66:67], v12 offset:512
  ds_read_b64_tr_b16 v[68:69], v12 offset:32
  ds_read_b64_tr_b16 v[70:71], v12 offset:544
  ds_read_b64_tr_b16 v[72:73], v12 offset:64
  ds_read_b64_tr_b16 v[74:75], v12 offset:576
  ds_read_b64_tr_b16 v[76:77], v12 offset:96
  ds_read_b64_tr_b16 v[78:79], v12 offset:608
  ds_read_b64_tr_b16 v[80:81], v12 offset:4096
  ds_read_b64_tr_b16 v[82:83], v12 offset:4608
  ds_read_b64_tr_b16 v[84:85], v12 offset:4128
  ds_read_b64_tr_b16 v[86:87], v12 offset:4640
  ds_read_b64_tr_b16 v[88:89], v12 offset:4160
  ds_read_b64_tr_b16 v[90:91], v12 offset:4672
  ds_read_b64_tr_b16 v[92:93], v12 offset:4192
  ds_read_b64_tr_b16 v[94:95], v12 offset:4704
  s_mov_b32 s62, 400000
  v_lshlrev_b32 v37, 2, v1
  s_mov_b64 exec, 15
PF_5:
  buffer_load_dword v36, v37, s[48:51], 0 offen offset:128 sc1
  s_waitcnt vmcnt(0)
  v_cmp_eq_u32 vcc, 0, v36
  s_cbranch_vccz PFD_6
  s_sub_u32 s62, s62, 1
  s_cbranch_scc1 PFD_6
  s_sleep 1
  s_branch PF_5
PFD_6:
  s_mov_b64 exec, -1
  s_mov_b32 s62, 400000
POLL_7:
  buffer_load_dword v36, v7, s[40:43], s57 offen sc1
  buffer_load_dword v37, v7, s[40:43], s57 offen offset:2048 sc1
  s_waitcnt vmcnt(0)
  v_max_u32 v112, v36, v37
  v_cmp_eq_u32 vcc, -1, v112
  s_cbranch_vccz POLLD_8
  s_sub_u32 s62, s62, 1
  s_cbranch_scc1 POLLD_8
  s_sleep 1
  s_branch POLL_7
POLLD_8:
  v_lshlrev_b32 v112, 16, v37
  v_and_b32 v113, 0xffff0000, v37
  v_add_f32 v112, 1.0, v112
  v_add_f32 v113, 1.0, v113
  v_cvt_pk_bf16_f32 v116, v112, v113
  v_lshlrev_b32 v112, 16, v116
  v_and_b32 v113, 0xffff0000, v116
  v_mul_f32 v112, v38, v112
  v_mul_f32 v113, v39, v113
  v_cvt_pk_bf16_f32 v116, v112, v113
  v_lshlrev_b32 v112, 16, v116
  v_and_b32 v113, 0xffff0000, v116
  v_lshlrev_b32 v114, 16, v36
  v_and_b32 v115, 0xffff0000, v36
  v_add_f32 v112, v112, v114
  v_add_f32 v113, v113, v115
  v_cvt_pk_bf16_f32 v36, v112, v113
  ds_write_b32 v13, v36
  s_waitcnt lgkmcnt(0)
  ds_read_b128 v[40:43], v120 offset:0
  ds_read_b128 v[44:47], v120 offset:64
  s_waitcnt lgkmcnt(1)
  v_mfma_f32_16x16x32_bf16 v[48:51], v[64:67], v[40:43], 0
  v_mfma_f32_16x16x32_bf16 v[52:55], v[68:71], v[40:43], 0
  v_mfma_f32_16x16x32_bf16 v[56:59], v[72:75], v[40:43], 0
  v_mfma_f32_16x16x32_bf16 v[60:63], v[76:79], v[40:43], 0
  s_waitcnt lgkmcnt(0)
  v_mfma_f32_16x16x32_bf16 v[48:51], v[80:83], v[44:47], v[48:51]
  v_mfma_f32_16x16x32_bf16 v[52:55], v[84:87], v[44:47], v[52:55]
  v_mfma_f32_16x16x32_bf16 v[56:59], v[88:91], v[44:47], v[56:59]
  v_mfma_f32_16x16x32_bf16 v[60:63], v[92:95], v[44:47], v[60:63]
  s_mov_b32 exec_lo, 0x00030003
  s_mov_b32 exec_hi, 0x00030003
  s_nop 5
  ds_write_b128 v121, v[48:51] offset:0
  ds_write_b128 v121, v[52:55] offset:128
  ds_write_b128 v121, v[56:59] offset:256
  ds_write_b128 v121, v[60:63] offset:384
  s_mov_b64 exec, -1
  s_waitcnt lgkmcnt(0)
  s_barrier
  s_cmp_eq_u32 s3, 0
  s_cbranch_scc0 L_Q3
  v_lshlrev_b32 v12, 3, v1
  v_add_u32 v12, 133120, v12
  ds_read_b64 v[48:49], v12 offset:0
  ds_read_b64 v[50:51], v12 offset:512
  ds_read_b64 v[52:53], v12 offset:1024
  ds_read_b64 v[54:55], v12 offset:1536
  ds_read_b64 v[56:57], v12 offset:2048
  ds_read_b64 v[58:59], v12 offset:2560
  ds_read_b64 v[60:61], v12 offset:3072
  ds_read_b64 v[62:63], v12 offset:3584
  s_waitcnt lgkmcnt(6)
  v_pk_add_f32 v[48:49], v[48:49], v[50:51]
  s_waitcnt lgkmcnt(5)
  v_pk_add_f32 v[48:49], v[48:49], v[52:53]
  s_waitcnt lgkmcnt(4)
  v_pk_add_f32 v[48:49], v[48:49], v[54:55]
  s_waitcnt lgkmcnt(3)
  v_pk_add_f32 v[48:49], v[48:49], v[56:57]
  s_waitcnt lgkmcnt(2)
  v_pk_add_f32 v[48:49], v[48:49], v[58:59]
  s_waitcnt lgkmcnt(1)
  v_pk_add_f32 v[48:49], v[48:49], v[60:61]
  s_waitcnt lgkmcnt(0)
  v_pk_add_f32 v[48:49], v[48:49], v[62:63]
  v_cvt_pk_bf16_f32 v48, v48, v49
  v_bfe_u32 v4, v1, 3, 1
  v_lshlrev_b32 v4, 13, v4
  v_lshl_add_u32 v4, v6, 5, v4
  v_and_b32 v7, 7, v1
  v_lshl_add_u32 v4, v7, 2, v4
  s_lshl_b32 s57, s69, 7
  s_add_u32 s57, s57, 4096
  buffer_store_dword v48, v4, s[40:43], s57 offen sc1
L_Q3:
  s_barrier
L_FILL:
  s_cmp_lt_u32 s3, 4
  s_cselect_b32 s81, 1, 0
  s_cbranch_scc1 L_FILLP
  s_setprio 3
L_FILLP:
  s_mov_b32 s6, s66
  s_mov_b32 s7, s66
  s_mov_b32 s8, 0x11111111
  s_mov_b32 s9, 0x11111111
  s_mov_b32 s96, 0
  s_mov_b32 s97, 0
  s_cmp_lt_u32 s3, 4
  s_cbranch_scc1 L_F1
  s_cmp_eq_u32 s68, 0
  s_cbranch_scc0 L_F1
  s_lshl_b32 s59, s30, 19
  s_lshl_b32 s57, s70, 7
  s_add_u32 s59, s59, s57
  s_mov_b32 s44, s12
  s_mov_b32 s45, s13
  s_mov_b32 s46, 4194304
  s_mov_b32 s47, 0x00020000
  v_lshrrev_b32 v4, 3, v1
  v_mul_u32_u24 v4, 1024, v4
  v_and_b32 v7, 7, v1
  v_lshl_add_u32 v4, v7, 4, v4
  s_mul_i32 s56, s82, 131072
  s_add_u32 s56, s56, s59
  s_mul_i32 s58, s82, 16384
  s_add_u32 s58, s58, 32768
  s_mov_b32 m0, s58
  s_add_u32 s58, s58, 1024
  buffer_load_dwordx4 v4, s[44:47], s56 offen  lds
  s_add_u32 s56, s56, 8192
  s_mov_b32 m0, s58
  s_add_u32 s58, s58, 1024
  buffer_load_dwordx4 v4, s[44:47], s56 offen  lds
  s_add_u32 s56, s56, 8192
  s_mov_b32 m0, s58
  s_add_u32 s58, s58, 1024
  buffer_load_dwordx4 v4, s[44:47], s56 offen  lds
  s_add_u32 s56, s56, 8192
  s_mov_b32 m0, s58
  s_add_u32 s58, s58, 1024
  buffer_load_dwordx4 v4, s[44:47], s56 offen  lds
  s_add_u32 s56, s56, 8192
  s_mov_b32 m0, s58
  s_add_u32 s58, s58, 1024
  buffer_load_dwordx4 v4, s[44:47], s56 offen  lds
  s_add_u32 s56, s56, 8192
  s_mov_b32 m0, s58
  s_add_u32 s58, s58, 1024
  buffer_load_dwordx4 v4, s[44:47], s56 offen  lds
  s_add_u32 s56, s56, 8192
  s_mov_b32 m0, s58
  s_add_u32 s58, s58, 1024
  buffer_load_dwordx4 v4, s[44:47], s56 offen  lds
  s_add_u32 s56, s56, 8192
  s_mov_b32 m0, s58
  s_add_u32 s58, s58, 1024
  buffer_load_dwordx4 v4, s[44:47], s56 offen  lds
  s_add_u32 s56, s56, 8192
  s_mov_b32 m0, s58
  s_add_u32 s58, s58, 1024
  buffer_load_dwordx4 v4, s[44:47], s56 offen  lds
  s_add_u32 s56, s56, 8192
  s_mov_b32 m0, s58
  s_add_u32 s58, s58, 1024
  buffer_load_dwordx4 v4, s[44:47], s56 offen  lds
  s_add_u32 s56, s56, 8192
  s_mov_b32 m0, s58
  s_add_u32 s58, s58, 1024
  buffer_load_dwordx4 v4, s[44:47], s56 offen  lds
  s_add_u32 s56, s56, 8192
  s_mov_b32 m0, s58
  s_add_u32 s58, s58, 1024
  buffer_load_dwordx4 v4, s[44:47], s56 offen  lds
  s_add_u32 s56, s56, 8192
  s_mov_b32 m0, s58
  s_add_u32 s58, s58, 1024
  buffer_load_dwordx4 v4, s[44:47], s56 offen  lds
  s_add_u32 s56, s56, 8192
  s_mov_b32 m0, s58
  s_add_u32 s58, s58, 1024
  buffer_load_dwordx4 v4, s[44:47], s56 offen  lds
  s_add_u32 s56, s56, 8192
  s_mov_b32 m0, s58
  s_add_u32 s58, s58, 1024
  buffer_load_dwordx4 v4, s[44:47], s56 offen  lds
  s_add_u32 s56, s56, 8192
  s_mov_b32 m0, s58
  s_add_u32 s58, s58, 1024
  buffer_load_dwordx4 v4, s[44:47], s56 offen  lds
L_F1:
  s_cmp_eq_u32 s98, 1
  s_cbranch_scc1 L_F1B
  s_add_u32 s75, s72, s95
  s_and_b32 s75, s75, 1023
  s_lshr_b32 s60, s75, 6
  s_lshl_b32 s60, s60, 3
  s_and_b32 s61, s75, 7
  s_or_b32 s60, s60, s61
  s_and_b32 s61, s60, 7
  s_lshr_b32 s60, s60, 3
  s_lshl_b32 s60, s60, 4
  s_or_b32 s60, s60, s61
  s_bfe_u32 s61, s75, 196611
  s_lshl_b32 s61, s61, 8
  s_or_b32 s60, s60, s61
  s_lshl_b32 s60, s60, 12
  s_cmp_lt_u32 s72, 1024
  s_cselect_b32 s60, s60, 8388608
  s_add_u32 s61, s60, 32768
  buffer_load_dwordx4 v[128:131], v2, s[32:35], s60 offen offset:0 nt
  buffer_load_dwordx4 v[132:135], v2, s[32:35], s60 offen offset:1024 nt
  buffer_load_dwordx4 v[136:139], v2, s[32:35], s60 offen offset:2048 nt
  buffer_load_dwordx4 v[140:143], v2, s[32:35], s60 offen offset:3072 nt
  buffer_load_dwordx4 v[144:147], v2, s[32:35], s61 offen offset:0 nt
  buffer_load_dwordx4 v[148:151], v2, s[32:35], s61 offen offset:1024 nt
  buffer_load_dwordx4 v[152:155], v2, s[32:35], s61 offen offset:2048 nt
  buffer_load_dwordx4 v[156:159], v2, s[32:35], s61 offen offset:3072 nt
  buffer_load_dwordx4 v[160:163], v3, s[36:39], s60 offen offset:0 nt
  buffer_load_dwordx4 v[164:167], v3, s[36:39], s60 offen offset:1024 nt
  buffer_load_dwordx4 v[168:171], v3, s[36:39], s60 offen offset:2048 nt
  buffer_load_dwordx4 v[172:175], v3, s[36:39], s60 offen offset:3072 nt
  buffer_load_dwordx4 v[176:179], v3, s[36:39], s61 offen offset:0 nt
  buffer_load_dwordx4 v[180:183], v3, s[36:39], s61 offen offset:1024 nt
  buffer_load_dwordx4 v[184:187], v3, s[36:39], s61 offen offset:2048 nt
  buffer_load_dwordx4 v[188:191], v3, s[36:39], s61 offen offset:3072 nt
L_F1B:
  v_mov_b32 v36, 0
  s_cmp_eq_u32 s3, 7
  s_cbranch_scc0 L_F1C
  v_lshlrev_b32 v37, 2, v1
  s_mov_b64 exec, 15
  buffer_load_dword v36, v37, s[48:51], 0 offen offset:128 sc1
  s_mov_b64 exec, -1
L_F1C:
  s_add_u32 s75, s73, s95
  s_and_b32 s75, s75, 1023
  s_lshr_b32 s60, s75, 6
  s_lshl_b32 s60, s60, 3
  s_and_b32 s61, s75, 7
  s_or_b32 s60, s60, s61
  s_and_b32 s61, s60, 7
  s_lshr_b32 s60, s60, 3
  s_lshl_b32 s60, s60, 4
  s_or_b32 s60, s60, s61
  s_bfe_u32 s61, s75, 196611
  s_lshl_b32 s61, s61, 8
  s_or_b32 s60, s60, s61
  s_lshl_b32 s60, s60, 12
  s_cmp_lt_u32 s73, 1024
  s_cselect_b32 s60, s60, 8388608
  s_add_u32 s61, s60, 32768
  buffer_load_dwordx4 v[192:195], v2, s[32:35], s60 offen offset:0 nt
  buffer_load_dwordx4 v[196:199], v2, s[32:35], s60 offen offset:1024 nt
  buffer_load_dwordx4 v[200:203], v2, s[32:35], s60 offen offset:2048 nt
  buffer_load_dwordx4 v[204:207], v2, s[32:35], s60 offen offset:3072 nt
  buffer_load_dwordx4 v[208:211], v2, s[32:35], s61 offen offset:0 nt
  buffer_load_dwordx4 v[212:215], v2, s[32:35], s61 offen offset:1024 nt
  buffer_load_dwordx4 v[216:219], v2, s[32:35], s61 offen offset:2048 nt
  buffer_load_dwordx4 v[220:223], v2, s[32:35], s61 offen offset:3072 nt
  buffer_load_dwordx4 v[224:227], v3, s[36:39], s60 offen offset:0 nt
  buffer_load_dwordx4 v[228:231], v3, s[36:39], s60 offen offset:1024 nt
  buffer_load_dwordx4 v[232:235], v3, s[36:39], s60 offen offset:2048 nt
  buffer_load_dwordx4 v[236:239], v3, s[36:39], s60 offen offset:3072 nt
  buffer_load_dwordx4 v[240:243], v3, s[36:39], s61 offen offset:0 nt
  buffer_load_dwordx4 v[244:247], v3, s[36:39], s61 offen offset:1024 nt
  buffer_load_dwordx4 v[248:251], v3, s[36:39], s61 offen offset:2048 nt
  buffer_load_dwordx4 v[252:255], v3, s[36:39], s61 offen offset:3072 nt
  v_mov_b32 v20, 0xff7fffff
  v_mov_b32 v21, 0
  v_mov_b32 v80, 0
  v_mov_b32 v81, 0
  v_mov_b32 v82, 0
  v_mov_b32 v83, 0
  v_mov_b32 v84, 0
  v_mov_b32 v85, 0
  v_mov_b32 v86, 0
  v_mov_b32 v87, 0
  v_mov_b32 v88, 0
  v_mov_b32 v89, 0
  v_mov_b32 v90, 0
  v_mov_b32 v91, 0
  v_mov_b32 v92, 0
  v_mov_b32 v93, 0
  v_mov_b32 v94, 0
  v_mov_b32 v95, 0
  v_mov_b32 v96, 0
  v_mov_b32 v97, 0
  v_mov_b32 v98, 0
  v_mov_b32 v99, 0
  v_mov_b32 v100, 0
  v_mov_b32 v101, 0
  v_mov_b32 v102, 0
  v_mov_b32 v103, 0
  v_mov_b32 v104, 0
  v_mov_b32 v105, 0
  v_mov_b32 v106, 0
  v_mov_b32 v107, 0
  v_mov_b32 v108, 0
  v_mov_b32 v109, 0
  v_mov_b32 v110, 0
  v_mov_b32 v111, 0
  v_lshrrev_b32 v4, 2, v5
  v_lshlrev_b32 v7, 9, v4
  v_lshl_add_u32 v7, v6, 7, v7
  s_lshl_b32 s56, s3, 11
  s_add_u32 s56, s56, 114688
  v_add_u32 v122, s56, v7
  v_lshlrev_b32 v4, 6, v4
  s_lshl_b32 s56, s3, 3
  s_add_u32 s56, s56, 137216
  v_add_u32 v123, s56, v4
  v_add_u32 v7, 137728, v3
  s_cmp_eq_u32 s3, 6
  s_cbranch_scc0 L_QF1
  s_mov_b32 s62, 400000
  v_lshlrev_b32 v37, 2, v1
  s_mov_b64 exec, 16
PF_9:
  buffer_load_dword v36, v37, s[48:51], 0 offen offset:128 sc1
  s_waitcnt vmcnt(0)
  v_cmp_eq_u32 vcc, 0, v36
  s_cbranch_vccz PFD_10
  s_sub_u32 s62, s62, 1
  s_cbranch_scc1 PFD_10
  s_sleep 2
  s_branch PF_9
PFD_10:
  s_mov_b64 exec, -1
  s_branch L_QBAR
L_QF1:
  s_cmp_eq_u32 s3, 7
  s_cbranch_scc0 L_QBAR
  s_waitcnt vmcnt(16)
  s_mov_b64 exec, 15
  v_cmp_eq_u32 vcc, 0, v36
  s_mov_b64 exec, -1
  s_cbranch_vccz L_QF2
  s_mov_b32 s62, 400000
  v_lshlrev_b32 v37, 2, v1
  s_mov_b64 exec, 15
PF_11:
  buffer_load_dword v36, v37, s[48:51], 0 offen offset:128 sc1
  s_waitcnt vmcnt(0)
  v_cmp_eq_u32 vcc, 0, v36
  s_cbranch_vccz PFD_12
  s_sub_u32 s62, s62, 1
  s_cbranch_scc1 PFD_12
  s_sleep 2
  s_branch PF_11
PFD_12:
  s_mov_b64 exec, -1
L_QF2:
  s_lshl_b32 s57, s76, 10
  s_add_u32 s57, s57, 4096
  s_mov_b32 s62, 400000
POLL_13:
  buffer_load_dwordx4 v[16:19], v2, s[40:43], s57 offen sc1
  s_waitcnt vmcnt(0)
  v_max3_u32 v112, v16, v17, v18
  v_max_u32 v112, v112, v19
  v_cmp_eq_u32 vcc, -1, v112
  s_cbranch_vccz POLLD_14
  s_sub_u32 s62, s62, 1
  s_cbranch_scc1 POLLD_14
  s_sleep 2
  s_branch POLL_13
POLLD_14:
  ds_write_b128 v7, v[16:19]
  s_waitcnt lgkmcnt(0)
L_QBAR:
  s_barrier
  ds_read_b128 v[16:19], v7
  s_waitcnt lgkmcnt(0)
L_LOOP:
  s_cmp_ge_u32 s72, 1024
  s_cbranch_scc1 L_DONE
  s_waitcnt vmcnt(24)
  s_cmp_lt_u32 s73, 1024
  s_cbranch_scc1 WK_15
  s_waitcnt vmcnt(8)
WK_15:
  s_mov_b32 s80, 2048
  s_cmp_eq_u32 s81, 0
  s_cbranch_scc1 TKR_16
  s_mov_b32 s80, 1
  s_atomic_add s80, s[78:79], 0 glc
TKR_16:
  v_mfma_f32_16x16x32_bf16 v[48:51], v[128:131], v[16:19], 0
  v_mfma_f32_16x16x32_bf16 v[52:55], v[132:135], v[16:19], 0
  v_mfma_f32_16x16x32_bf16 v[56:59], v[136:139], v[16:19], 0
  v_mfma_f32_16x16x32_bf16 v[60:63], v[140:143], v[16:19], 0
  v_mfma_f32_16x16x32_bf16 v[64:67], v[144:147], v[16:19], 0
  v_mfma_f32_16x16x32_bf16 v[68:71], v[148:151], v[16:19], 0
  v_mfma_f32_16x16x32_bf16 v[72:75], v[152:155], v[16:19], 0
  v_mfma_f32_16x16x32_bf16 v[76:79], v[156:159], v[16:19], 0
  s_nop 1
  v_add_f32_dpp v24, v49, v48 quad_perm:[1,1,1,1] row_mask:0xf bank_mask:0xf
  v_add_f32_dpp v24, v50, v24 quad_perm:[2,2,2,2] row_mask:0xf bank_mask:0xf
  v_add_f32_dpp v24, v51, v24 quad_perm:[3,3,3,3] row_mask:0xf bank_mask:0xf
  v_add_f32_dpp v25, v53, v52 quad_perm:[1,1,1,1] row_mask:0xf bank_mask:0xf
  v_add_f32_dpp v25, v54, v25 quad_perm:[2,2,2,2] row_mask:0xf bank_mask:0xf
  v_add_f32_dpp v25, v55, v25 quad_perm:[3,3,3,3] row_mask:0xf bank_mask:0xf
  v_add_f32_dpp v26, v57, v56 quad_perm:[1,1,1,1] row_mask:0xf bank_mask:0xf
  v_add_f32_dpp v26, v58, v26 quad_perm:[2,2,2,2] row_mask:0xf bank_mask:0xf
  v_add_f32_dpp v26, v59, v26 quad_perm:[3,3,3,3] row_mask:0xf bank_mask:0xf
  v_add_f32_dpp v27, v61, v60 quad_perm:[1,1,1,1] row_mask:0xf bank_mask:0xf
  v_add_f32_dpp v27, v62, v27 quad_perm:[2,2,2,2] row_mask:0xf bank_mask:0xf
  v_add_f32_dpp v27, v63, v27 quad_perm:[3,3,3,3] row_mask:0xf bank_mask:0xf
  v_add_f32_dpp v28, v65, v64 quad_perm:[1,1,1,1] row_mask:0xf bank_mask:0xf
  v_add_f32_dpp v28, v66, v28 quad_perm:[2,2,2,2] row_mask:0xf bank_mask:0xf
  v_add_f32_dpp v28, v67, v28 quad_perm:[3,3,3,3] row_mask:0xf bank_mask:0xf
  v_add_f32_dpp v29, v69, v68 quad_perm:[1,1,1,1] row_mask:0xf bank_mask:0xf
  v_add_f32_dpp v29, v70, v29 quad_perm:[2,2,2,2] row_mask:0xf bank_mask:0xf
  v_add_f32_dpp v29, v71, v29 quad_perm:[3,3,3,3] row_mask:0xf bank_mask:0xf
  v_add_f32_dpp v30, v73, v72 quad_perm:[1,1,1,1] row_mask:0xf bank_mask:0xf
  v_add_f32_dpp v30, v74, v30 quad_perm:[2,2,2,2] row_mask:0xf bank_mask:0xf
  v_add_f32_dpp v30, v75, v30 quad_perm:[3,3,3,3] row_mask:0xf bank_mask:0xf
  v_add_f32_dpp v31, v77, v76 quad_perm:[1,1,1,1] row_mask:0xf bank_mask:0xf
  v_add_f32_dpp v31, v78, v31 quad_perm:[2,2,2,2] row_mask:0xf bank_mask:0xf
  v_add_f32_dpp v31, v79, v31 quad_perm:[3,3,3,3] row_mask:0xf bank_mask:0xf
  v_cvt_pk_bf16_f32 v112, v24, v25
  v_lshlrev_b32 v24, 16, v112
  v_and_b32 v25, 0xffff0000, v112
  v_mul_f32 v24, s66, v24
  v_mul_f32 v25, s66, v25
  v_cvt_pk_bf16_f32 v112, v24, v25
  v_lshlrev_b32 v24, 16, v112
  v_and_b32 v25, 0xffff0000, v112
  v_cvt_pk_bf16_f32 v112, v26, v27
  v_lshlrev_b32 v26, 16, v112
  v_and_b32 v27, 0xffff0000, v112
  v_mul_f32 v26, s66, v26
  v_mul_f32 v27, s66, v27
  v_cvt_pk_bf16_f32 v112, v26, v27
  v_lshlrev_b32 v26, 16, v112
  v_and_b32 v27, 0xffff0000, v112
  v_cvt_pk_bf16_f32 v112, v28, v29
  v_lshlrev_b32 v28, 16, v112
  v_and_b32 v29, 0xffff0000, v112
  v_mul_f32 v28, s66, v28
  v_mul_f32 v29, s66, v29
  v_cvt_pk_bf16_f32 v112, v28, v29
  v_lshlrev_b32 v28, 16, v112
  v_and_b32 v29, 0xffff0000, v112
  v_cvt_pk_bf16_f32 v112, v30, v31
  v_lshlrev_b32 v30, 16, v112
  v_and_b32 v31, 0xffff0000, v112
  v_mul_f32 v30, s66, v30
  v_mul_f32 v31, s66, v31
  v_cvt_pk_bf16_f32 v112, v30, v31
  v_lshlrev_b32 v30, 16, v112
  v_and_b32 v31, 0xffff0000, v112
  v_max3_f32 v112, v24, v25, v26
  v_max3_f32 v112, v112, v27, v28
  v_max3_f32 v112, v112, v29, v30
  v_max3_f32 v112, v112, v31, v20
  v_mov_b32 v113, v112
  s_nop 1
  v_permlane16_swap_b32 v112, v113
  v_max_f32 v112, v112, v113
  v_mov_b32 v113, v112
  s_nop 1
  v_permlane32_swap_b32 v112, v113
  v_max_f32 v112, v112, v113
  v_sub_f32 v22, v20, v112
  v_mul_f32 v22, s65, v22
  v_exp_f32 v22, v22
  v_mov_b32 v20, v112
  v_mul_f32 v23, s65, v112
  v_fma_f32 v24, v24, s65, -v23
  v_fma_f32 v25, v25, s65, -v23
  v_fma_f32 v26, v26, s65, -v23
  v_fma_f32 v27, v27, s65, -v23
  v_fma_f32 v28, v28, s65, -v23
  v_fma_f32 v29, v29, s65, -v23
  v_fma_f32 v30, v30, s65, -v23
  v_fma_f32 v31, v31, s65, -v23
  v_exp_f32 v24, v24
  v_exp_f32 v25, v25
  v_exp_f32 v26, v26
  v_exp_f32 v27, v27
  v_exp_f32 v28, v28
  v_exp_f32 v29, v29
  v_exp_f32 v30, v30
  v_exp_f32 v31, v31
  v_mul_f32 v21, v21, v22
  v_add_f32 v21, v21, v24
  v_add_f32 v21, v21, v25
  v_add_f32 v21, v21, v26
  v_add_f32 v21, v21, v27
  v_add_f32 v21, v21, v28
  v_add_f32 v21, v21, v29
  v_add_f32 v21, v21, v30
  v_add_f32 v21, v21, v31
  v_cvt_pk_bf16_f32 v32, v24, v25
  v_cvt_pk_bf16_f32 v33, v26, v27
  v_cvt_pk_bf16_f32 v34, v28, v29
  v_cvt_pk_bf16_f32 v35, v30, v31
  v_pk_mul_f32 v[80:81], v[80:81], v[22:23] op_sel_hi:[1,0]
  v_pk_mul_f32 v[82:83], v[82:83], v[22:23] op_sel_hi:[1,0]
  v_pk_mul_f32 v[84:85], v[84:85], v[22:23] op_sel_hi:[1,0]
  v_pk_mul_f32 v[86:87], v[86:87], v[22:23] op_sel_hi:[1,0]
  v_pk_mul_f32 v[88:89], v[88:89], v[22:23] op_sel_hi:[1,0]
  v_pk_mul_f32 v[90:91], v[90:91], v[22:23] op_sel_hi:[1,0]
  v_pk_mul_f32 v[92:93], v[92:93], v[22:23] op_sel_hi:[1,0]
  v_pk_mul_f32 v[94:95], v[94:95], v[22:23] op_sel_hi:[1,0]
  v_pk_mul_f32 v[96:97], v[96:97], v[22:23] op_sel_hi:[1,0]
  v_pk_mul_f32 v[98:99], v[98:99], v[22:23] op_sel_hi:[1,0]
  v_pk_mul_f32 v[100:101], v[100:101], v[22:23] op_sel_hi:[1,0]
  v_pk_mul_f32 v[102:103], v[102:103], v[22:23] op_sel_hi:[1,0]
  v_pk_mul_f32 v[104:105], v[104:105], v[22:23] op_sel_hi:[1,0]
  v_pk_mul_f32 v[106:107], v[106:107], v[22:23] op_sel_hi:[1,0]
  v_pk_mul_f32 v[108:109], v[108:109], v[22:23] op_sel_hi:[1,0]
  v_pk_mul_f32 v[110:111], v[110:111], v[22:23] op_sel_hi:[1,0]
  s_waitcnt lgkmcnt(0)
  s_add_u32 s72, s80, 257
  s_add_u32 s96, s72, 1
  s_cmp_lt_u32 s72, 1024
  s_cselect_b32 s81, 1, 0
  s_add_u32 s75, s72, s95
  s_and_b32 s75, s75, 1023
  s_lshr_b32 s60, s75, 6
  s_lshl_b32 s60, s60, 3
  s_and_b32 s61, s75, 7
  s_or_b32 s60, s60, s61
  s_and_b32 s61, s60, 7
  s_lshr_b32 s60, s60, 3
  s_lshl_b32 s60, s60, 4
  s_or_b32 s60, s60, s61
  s_bfe_u32 s61, s75, 196611
  s_lshl_b32 s61, s61, 8
  s_or_b32 s60, s60, s61
  s_lshl_b32 s60, s60, 12
  s_cmp_lt_u32 s72, 1024
  s_cselect_b32 s60, s60, 8388608
  s_add_u32 s61, s60, 32768
  s_cmp_ge_u32 s72, 1024
  s_cbranch_scc1 SKIP_17
  buffer_load_dwordx4 v[128:131], v2, s[32:35], s60 offen offset:0 nt
  buffer_load_dwordx4 v[132:135], v2, s[32:35], s60 offen offset:1024 nt
  buffer_load_dwordx4 v[136:139], v2, s[32:35], s60 offen offset:2048 nt
  buffer_load_dwordx4 v[140:143], v2, s[32:35], s60 offen offset:3072 nt
  buffer_load_dwordx4 v[144:147], v2, s[32:35], s61 offen offset:0 nt
  buffer_load_dwordx4 v[148:151], v2, s[32:35], s61 offen offset:1024 nt
  buffer_load_dwordx4 v[152:155], v2, s[32:35], s61 offen offset:2048 nt
  buffer_load_dwordx4 v[156:159], v2, s[32:35], s61 offen offset:3072 nt
SKIP_17:
  s_waitcnt vmcnt(24)
  s_cmp_lt_u32 s72, 1024
  s_cbranch_scc1 WV_18
  s_waitcnt vmcnt(16)
  s_cmp_lt_u32 s73, 1024
  s_cbranch_scc1 WV_18
  s_waitcnt vmcnt(0)
WV_18:
  v_perm_b32 v36, v164, v160, s63
  v_perm_b32 v37, v172, v168, s63
  v_perm_b32 v38, v180, v176, s63
  v_perm_b32 v39, v188, v184, s63
  v_perm_b32 v40, v164, v160, s64
  v_perm_b32 v41, v172, v168, s64
  v_perm_b32 v42, v180, v176, s64
  v_perm_b32 v43, v188, v184, s64
  v_mfma_f32_16x16x32_bf16 v[80:83], v[36:39], v[32:35], v[80:83]
  v_perm_b32 v44, v165, v161, s63
  v_perm_b32 v45, v173, v169, s63
  v_perm_b32 v46, v181, v177, s63
  v_perm_b32 v47, v189, v185, s63
  v_mfma_f32_16x16x32_bf16 v[84:87], v[40:43], v[32:35], v[84:87]
  v_perm_b32 v36, v165, v161, s64
  v_perm_b32 v37, v173, v169, s64
  v_perm_b32 v38, v181, v177, s64
  v_perm_b32 v39, v189, v185, s64
  v_mfma_f32_16x16x32_bf16 v[88:91], v[44:47], v[32:35], v[88:91]
  v_perm_b32 v40, v166, v162, s63
  v_perm_b32 v41, v174, v170, s63
  v_perm_b32 v42, v182, v178, s63
  v_perm_b32 v43, v190, v186, s63
  v_mfma_f32_16x16x32_bf16 v[92:95], v[36:39], v[32:35], v[92:95]
  v_perm_b32 v44, v166, v162, s64
  v_perm_b32 v45, v174, v170, s64
  v_perm_b32 v46, v182, v178, s64
  v_perm_b32 v47, v190, v186, s64
  v_mfma_f32_16x16x32_bf16 v[96:99], v[40:43], v[32:35], v[96:99]
  v_perm_b32 v36, v167, v163, s63
  v_perm_b32 v37, v175, v171, s63
  v_perm_b32 v38, v183, v179, s63
  v_perm_b32 v39, v191, v187, s63
  v_mfma_f32_16x16x32_bf16 v[100:103], v[44:47], v[32:35], v[100:103]
  v_perm_b32 v40, v167, v163, s64
  v_perm_b32 v41, v175, v171, s64
  v_perm_b32 v42, v183, v179, s64
  v_perm_b32 v43, v191, v187, s64
  v_mfma_f32_16x16x32_bf16 v[104:107], v[36:39], v[32:35], v[104:107]
  s_nop 1
  v_mfma_f32_16x16x32_bf16 v[108:111], v[40:43], v[32:35], v[108:111]
  s_cmp_ge_u32 s72, 1024
  s_cbranch_scc1 SKIP_19
  buffer_load_dwordx4 v[160:163], v3, s[36:39], s60 offen offset:0 nt
  buffer_load_dwordx4 v[164:167], v3, s[36:39], s60 offen offset:1024 nt
  buffer_load_dwordx4 v[168:171], v3, s[36:39], s60 offen offset:2048 nt
  buffer_load_dwordx4 v[172:175], v3, s[36:39], s60 offen offset:3072 nt
  buffer_load_dwordx4 v[176:179], v3, s[36:39], s61 offen offset:0 nt
  buffer_load_dwordx4 v[180:183], v3, s[36:39], s61 offen offset:1024 nt
  buffer_load_dwordx4 v[184:187], v3, s[36:39], s61 offen offset:2048 nt
  buffer_load_dwordx4 v[188:191], v3, s[36:39], s61 offen offset:3072 nt
SKIP_19:
  s_cmp_ge_u32 s73, 1024
  s_cbranch_scc1 L_DONE
  s_waitcnt vmcnt(24)
  s_cmp_lt_u32 s72, 1024
  s_cbranch_scc1 WK_20
  s_waitcnt vmcnt(8)
WK_20:
  s_mov_b32 s80, 2048
  s_cmp_eq_u32 s81, 0
  s_cbranch_scc1 TKR_21
  s_mov_b32 s80, 1
  s_atomic_add s80, s[78:79], 0 glc
TKR_21:
  v_mfma_f32_16x16x32_bf16 v[48:51], v[192:195], v[16:19], 0
  v_mfma_f32_16x16x32_bf16 v[52:55], v[196:199], v[16:19], 0
  v_mfma_f32_16x16x32_bf16 v[56:59], v[200:203], v[16:19], 0
  v_mfma_f32_16x16x32_bf16 v[60:63], v[204:207], v[16:19], 0
  v_mfma_f32_16x16x32_bf16 v[64:67], v[208:211], v[16:19], 0
  v_mfma_f32_16x16x32_bf16 v[68:71], v[212:215], v[16:19], 0
  v_mfma_f32_16x16x32_bf16 v[72:75], v[216:219], v[16:19], 0
  v_mfma_f32_16x16x32_bf16 v[76:79], v[220:223], v[16:19], 0
  s_nop 1
  v_add_f32_dpp v24, v49, v48 quad_perm:[1,1,1,1] row_mask:0xf bank_mask:0xf
  v_add_f32_dpp v24, v50, v24 quad_perm:[2,2,2,2] row_mask:0xf bank_mask:0xf
  v_add_f32_dpp v24, v51, v24 quad_perm:[3,3,3,3] row_mask:0xf bank_mask:0xf
  v_add_f32_dpp v25, v53, v52 quad_perm:[1,1,1,1] row_mask:0xf bank_mask:0xf
  v_add_f32_dpp v25, v54, v25 quad_perm:[2,2,2,2] row_mask:0xf bank_mask:0xf
  v_add_f32_dpp v25, v55, v25 quad_perm:[3,3,3,3] row_mask:0xf bank_mask:0xf
  v_add_f32_dpp v26, v57, v56 quad_perm:[1,1,1,1] row_mask:0xf bank_mask:0xf
  v_add_f32_dpp v26, v58, v26 quad_perm:[2,2,2,2] row_mask:0xf bank_mask:0xf
  v_add_f32_dpp v26, v59, v26 quad_perm:[3,3,3,3] row_mask:0xf bank_mask:0xf
  v_add_f32_dpp v27, v61, v60 quad_perm:[1,1,1,1] row_mask:0xf bank_mask:0xf
  v_add_f32_dpp v27, v62, v27 quad_perm:[2,2,2,2] row_mask:0xf bank_mask:0xf
  v_add_f32_dpp v27, v63, v27 quad_perm:[3,3,3,3] row_mask:0xf bank_mask:0xf
  v_add_f32_dpp v28, v65, v64 quad_perm:[1,1,1,1] row_mask:0xf bank_mask:0xf
  v_add_f32_dpp v28, v66, v28 quad_perm:[2,2,2,2] row_mask:0xf bank_mask:0xf
  v_add_f32_dpp v28, v67, v28 quad_perm:[3,3,3,3] row_mask:0xf bank_mask:0xf
  v_add_f32_dpp v29, v69, v68 quad_perm:[1,1,1,1] row_mask:0xf bank_mask:0xf
  v_add_f32_dpp v29, v70, v29 quad_perm:[2,2,2,2] row_mask:0xf bank_mask:0xf
  v_add_f32_dpp v29, v71, v29 quad_perm:[3,3,3,3] row_mask:0xf bank_mask:0xf
  v_add_f32_dpp v30, v73, v72 quad_perm:[1,1,1,1] row_mask:0xf bank_mask:0xf
  v_add_f32_dpp v30, v74, v30 quad_perm:[2,2,2,2] row_mask:0xf bank_mask:0xf
  v_add_f32_dpp v30, v75, v30 quad_perm:[3,3,3,3] row_mask:0xf bank_mask:0xf
  v_add_f32_dpp v31, v77, v76 quad_perm:[1,1,1,1] row_mask:0xf bank_mask:0xf
  v_add_f32_dpp v31, v78, v31 quad_perm:[2,2,2,2] row_mask:0xf bank_mask:0xf
  v_add_f32_dpp v31, v79, v31 quad_perm:[3,3,3,3] row_mask:0xf bank_mask:0xf
  v_cvt_pk_bf16_f32 v112, v24, v25
  v_lshlrev_b32 v24, 16, v112
  v_and_b32 v25, 0xffff0000, v112
  v_mul_f32 v24, s66, v24
  v_mul_f32 v25, s66, v25
  v_cvt_pk_bf16_f32 v112, v24, v25
  v_lshlrev_b32 v24, 16, v112
  v_and_b32 v25, 0xffff0000, v112
  v_cvt_pk_bf16_f32 v112, v26, v27
  v_lshlrev_b32 v26, 16, v112
  v_and_b32 v27, 0xffff0000, v112
  v_mul_f32 v26, s66, v26
  v_mul_f32 v27, s66, v27
  v_cvt_pk_bf16_f32 v112, v26, v27
  v_lshlrev_b32 v26, 16, v112
  v_and_b32 v27, 0xffff0000, v112
  v_cvt_pk_bf16_f32 v112, v28, v29
  v_lshlrev_b32 v28, 16, v112
  v_and_b32 v29, 0xffff0000, v112
  v_mul_f32 v28, s66, v28
  v_mul_f32 v29, s66, v29
  v_cvt_pk_bf16_f32 v112, v28, v29
  v_lshlrev_b32 v28, 16, v112
  v_and_b32 v29, 0xffff0000, v112
  v_cvt_pk_bf16_f32 v112, v30, v31
  v_lshlrev_b32 v30, 16, v112
  v_and_b32 v31, 0xffff0000, v112
  v_mul_f32 v30, s66, v30
  v_mul_f32 v31, s66, v31
  v_cvt_pk_bf16_f32 v112, v30, v31
  v_lshlrev_b32 v30, 16, v112
  v_and_b32 v31, 0xffff0000, v112
  v_max3_f32 v112, v24, v25, v26
  v_max3_f32 v112, v112, v27, v28
  v_max3_f32 v112, v112, v29, v30
  v_max3_f32 v112, v112, v31, v20
  v_mov_b32 v113, v112
  s_nop 1
  v_permlane16_swap_b32 v112, v113
  v_max_f32 v112, v112, v113
  v_mov_b32 v113, v112
  s_nop 1
  v_permlane32_swap_b32 v112, v113
  v_max_f32 v112, v112, v113
  v_sub_f32 v22, v20, v112
  v_mul_f32 v22, s65, v22
  v_exp_f32 v22, v22
  v_mov_b32 v20, v112
  v_mul_f32 v23, s65, v112
  v_fma_f32 v24, v24, s65, -v23
  v_fma_f32 v25, v25, s65, -v23
  v_fma_f32 v26, v26, s65, -v23
  v_fma_f32 v27, v27, s65, -v23
  v_fma_f32 v28, v28, s65, -v23
  v_fma_f32 v29, v29, s65, -v23
  v_fma_f32 v30, v30, s65, -v23
  v_fma_f32 v31, v31, s65, -v23
  v_exp_f32 v24, v24
  v_exp_f32 v25, v25
  v_exp_f32 v26, v26
  v_exp_f32 v27, v27
  v_exp_f32 v28, v28
  v_exp_f32 v29, v29
  v_exp_f32 v30, v30
  v_exp_f32 v31, v31
  v_mul_f32 v21, v21, v22
  v_add_f32 v21, v21, v24
  v_add_f32 v21, v21, v25
  v_add_f32 v21, v21, v26
  v_add_f32 v21, v21, v27
  v_add_f32 v21, v21, v28
  v_add_f32 v21, v21, v29
  v_add_f32 v21, v21, v30
  v_add_f32 v21, v21, v31
  v_cvt_pk_bf16_f32 v32, v24, v25
  v_cvt_pk_bf16_f32 v33, v26, v27
  v_cvt_pk_bf16_f32 v34, v28, v29
  v_cvt_pk_bf16_f32 v35, v30, v31
  v_pk_mul_f32 v[80:81], v[80:81], v[22:23] op_sel_hi:[1,0]
  v_pk_mul_f32 v[82:83], v[82:83], v[22:23] op_sel_hi:[1,0]
  v_pk_mul_f32 v[84:85], v[84:85], v[22:23] op_sel_hi:[1,0]
  v_pk_mul_f32 v[86:87], v[86:87], v[22:23] op_sel_hi:[1,0]
  v_pk_mul_f32 v[88:89], v[88:89], v[22:23] op_sel_hi:[1,0]
  v_pk_mul_f32 v[90:91], v[90:91], v[22:23] op_sel_hi:[1,0]
  v_pk_mul_f32 v[92:93], v[92:93], v[22:23] op_sel_hi:[1,0]
  v_pk_mul_f32 v[94:95], v[94:95], v[22:23] op_sel_hi:[1,0]
  v_pk_mul_f32 v[96:97], v[96:97], v[22:23] op_sel_hi:[1,0]
  v_pk_mul_f32 v[98:99], v[98:99], v[22:23] op_sel_hi:[1,0]
  v_pk_mul_f32 v[100:101], v[100:101], v[22:23] op_sel_hi:[1,0]
  v_pk_mul_f32 v[102:103], v[102:103], v[22:23] op_sel_hi:[1,0]
  v_pk_mul_f32 v[104:105], v[104:105], v[22:23] op_sel_hi:[1,0]
  v_pk_mul_f32 v[106:107], v[106:107], v[22:23] op_sel_hi:[1,0]
  v_pk_mul_f32 v[108:109], v[108:109], v[22:23] op_sel_hi:[1,0]
  v_pk_mul_f32 v[110:111], v[110:111], v[22:23] op_sel_hi:[1,0]
  s_waitcnt lgkmcnt(0)
  s_add_u32 s73, s80, 257
  s_add_u32 s96, s73, 1
  s_cmp_lt_u32 s73, 1024
  s_cselect_b32 s81, 1, 0
  s_add_u32 s75, s73, s95
  s_and_b32 s75, s75, 1023
  s_lshr_b32 s60, s75, 6
  s_lshl_b32 s60, s60, 3
  s_and_b32 s61, s75, 7
  s_or_b32 s60, s60, s61
  s_and_b32 s61, s60, 7
  s_lshr_b32 s60, s60, 3
  s_lshl_b32 s60, s60, 4
  s_or_b32 s60, s60, s61
  s_bfe_u32 s61, s75, 196611
  s_lshl_b32 s61, s61, 8
  s_or_b32 s60, s60, s61
  s_lshl_b32 s60, s60, 12
  s_cmp_lt_u32 s73, 1024
  s_cselect_b32 s60, s60, 8388608
  s_add_u32 s61, s60, 32768
  s_cmp_ge_u32 s73, 1024
  s_cbranch_scc1 SKIP_22
  buffer_load_dwordx4 v[192:195], v2, s[32:35], s60 offen offset:0 nt
  buffer_load_dwordx4 v[196:199], v2, s[32:35], s60 offen offset:1024 nt
  buffer_load_dwordx4 v[200:203], v2, s[32:35], s60 offen offset:2048 nt
  buffer_load_dwordx4 v[204:207], v2, s[32:35], s60 offen offset:3072 nt
  buffer_load_dwordx4 v[208:211], v2, s[32:35], s61 offen offset:0 nt
  buffer_load_dwordx4 v[212:215], v2, s[32:35], s61 offen offset:1024 nt
  buffer_load_dwordx4 v[216:219], v2, s[32:35], s61 offen offset:2048 nt
  buffer_load_dwordx4 v[220:223], v2, s[32:35], s61 offen offset:3072 nt
SKIP_22:
  s_waitcnt vmcnt(24)
  s_cmp_lt_u32 s73, 1024
  s_cbranch_scc1 WV_23
  s_waitcnt vmcnt(16)
  s_cmp_lt_u32 s72, 1024
  s_cbranch_scc1 WV_23
  s_waitcnt vmcnt(0)
WV_23:
  v_perm_b32 v36, v228, v224, s63
  v_perm_b32 v37, v236, v232, s63
  v_perm_b32 v38, v244, v240, s63
  v_perm_b32 v39, v252, v248, s63
  v_perm_b32 v40, v228, v224, s64
  v_perm_b32 v41, v236, v232, s64
  v_perm_b32 v42, v244, v240, s64
  v_perm_b32 v43, v252, v248, s64
  v_mfma_f32_16x16x32_bf16 v[80:83], v[36:39], v[32:35], v[80:83]
  v_perm_b32 v44, v229, v225, s63
  v_perm_b32 v45, v237, v233, s63
  v_perm_b32 v46, v245, v241, s63
  v_perm_b32 v47, v253, v249, s63
  v_mfma_f32_16x16x32_bf16 v[84:87], v[40:43], v[32:35], v[84:87]
  v_perm_b32 v36, v229, v225, s64
  v_perm_b32 v37, v237, v233, s64
  v_perm_b32 v38, v245, v241, s64
  v_perm_b32 v39, v253, v249, s64
  v_mfma_f32_16x16x32_bf16 v[88:91], v[44:47], v[32:35], v[88:91]
  v_perm_b32 v40, v230, v226, s63
  v_perm_b32 v41, v238, v234, s63
  v_perm_b32 v42, v246, v242, s63
  v_perm_b32 v43, v254, v250, s63
  v_mfma_f32_16x16x32_bf16 v[92:95], v[36:39], v[32:35], v[92:95]
  v_perm_b32 v44, v230, v226, s64
  v_perm_b32 v45, v238, v234, s64
  v_perm_b32 v46, v246, v242, s64
  v_perm_b32 v47, v254, v250, s64
  v_mfma_f32_16x16x32_bf16 v[96:99], v[40:43], v[32:35], v[96:99]
  v_perm_b32 v36, v231, v227, s63
  v_perm_b32 v37, v239, v235, s63
  v_perm_b32 v38, v247, v243, s63
  v_perm_b32 v39, v255, v251, s63
  v_mfma_f32_16x16x32_bf16 v[100:103], v[44:47], v[32:35], v[100:103]
  v_perm_b32 v40, v231, v227, s64
  v_perm_b32 v41, v239, v235, s64
  v_perm_b32 v42, v247, v243, s64
  v_perm_b32 v43, v255, v251, s64
  v_mfma_f32_16x16x32_bf16 v[104:107], v[36:39], v[32:35], v[104:107]
  s_nop 1
  v_mfma_f32_16x16x32_bf16 v[108:111], v[40:43], v[32:35], v[108:111]
  s_cmp_ge_u32 s73, 1024
  s_cbranch_scc1 SKIP_24
  buffer_load_dwordx4 v[224:227], v3, s[36:39], s60 offen offset:0 nt
  buffer_load_dwordx4 v[228:231], v3, s[36:39], s60 offen offset:1024 nt
  buffer_load_dwordx4 v[232:235], v3, s[36:39], s60 offen offset:2048 nt
  buffer_load_dwordx4 v[236:239], v3, s[36:39], s60 offen offset:3072 nt
  buffer_load_dwordx4 v[240:243], v3, s[36:39], s61 offen offset:0 nt
  buffer_load_dwordx4 v[244:247], v3, s[36:39], s61 offen offset:1024 nt
  buffer_load_dwordx4 v[248:251], v3, s[36:39], s61 offen offset:2048 nt
  buffer_load_dwordx4 v[252:255], v3, s[36:39], s61 offen offset:3072 nt
SKIP_24:
  s_branch L_LOOP
L_DONE:
  v_mov_b32 v112, v21
  s_nop 1
  v_permlane16_swap_b32 v21, v112
  v_add_f32 v21, v21, v112
  v_mov_b32 v112, v21
  s_nop 1
  v_permlane32_swap_b32 v21, v112
  v_add_f32 v21, v21, v112
  s_mov_b32 exec_lo, 0x11111111
  s_mov_b32 exec_hi, 0x11111111
  ds_write_b128 v122, v[80:83] offset:0
  ds_write_b128 v122, v[84:87] offset:16
  ds_write_b128 v122, v[88:91] offset:32
  ds_write_b128 v122, v[92:95] offset:48
  ds_write_b128 v122, v[96:99] offset:64
  ds_write_b128 v122, v[100:103] offset:80
  ds_write_b128 v122, v[104:107] offset:96
  ds_write_b128 v122, v[108:111] offset:112
  s_mov_b64 exec, 0x1111
  ds_write_b64 v123, v[20:21]
  s_mov_b64 exec, -1
  s_cmp_ge_u32 s3, 4
  s_cbranch_scc1 L_HELP
  s_waitcnt lgkmcnt(0)
  s_barrier
  s_mov_b32 s44, s18
  s_mov_b32 s45, s19
  s_mov_b32 s46, 1835008
  s_mov_b32 s47, 0x00020000
  s_cmp_lt_u32 s3, 1
  s_cbranch_scc0 L_PF1
  v_lshrrev_b32 v4, 3, v1
  v_lshlrev_b32 v4, 10, v4
  v_and_b32 v7, 7, v1
  v_lshl_add_u32 v4, v7, 4, v4
  s_lshl_b32 s56, s31, 0
  s_add_u32 s56, s56, s3
  s_mul_i32 s56, s56, 57344
  s_lshl_b32 s57, s30, 7
  s_add_u32 s56, s56, s57
  buffer_load_dwordx4 v[48:51], v4, s[44:47], s56 offen
  s_add_u32 s56, s56, 8192
  buffer_load_dwordx4 v[52:55], v4, s[44:47], s56 offen
  s_add_u32 s56, s56, 8192
  buffer_load_dwordx4 v[56:59], v4, s[44:47], s56 offen
  s_add_u32 s56, s56, 8192
  buffer_load_dwordx4 v[60:63], v4, s[44:47], s56 offen
  s_add_u32 s56, s56, 8192
  buffer_load_dwordx4 v[64:67], v4, s[44:47], s56 offen
  s_add_u32 s56, s56, 8192
  buffer_load_dwordx4 v[68:71], v4, s[44:47], s56 offen
  s_add_u32 s56, s56, 8192
  buffer_load_dwordx4 v[72:75], v4, s[44:47], s56 offen
L_PF1:
  s_cmp_eq_u32 s68, 2
  s_cbranch_scc0 L_END
  s_waitcnt vmcnt(0)
  s_branch L_T5
L_HELP:
  s_waitcnt vmcnt(0)
  v_lshrrev_b32 v13, 5, v1
  s_cmp_eq_u32 s68, 1
  s_cbranch_scc0 L_H1
  s_mov_b32 s52, s4
  s_mov_b32 s53, s5
  s_mov_b32 s54, 2048
  s_mov_b32 s55, 0x00020000
  v_and_b32 v4, 31, v1
  v_lshlrev_b32 v4, 3, v4
  v_lshl_add_u32 v4, v13, 2, v4
  s_lshl_b32 s56, s71, 10
  s_lshl_b32 s57, s82, 8
  s_add_u32 s56, s56, s57
  buffer_load_dword v36, v4, s[52:55], s56 offen
  v_bfe_u32 v7, v1, 3, 2
  v_lshlrev_b32 v7, 7, v7
  v_and_b32 v4, 7, v1
  v_lshl_add_u32 v7, v4, 3, v7
  v_lshl_add_u32 v7, v13, 2, v7
  s_lshl_b32 s56, s71, 6
  s_lshl_b32 s57, s82, 9
  s_add_u32 s56, s56, s57
  s_add_u32 s56, s56, 20480
  s_add_u32 s57, s56, 4096
  s_mov_b32 s62, 400000
POLL_25:
  buffer_load_dword v37, v7, s[40:43], s56 offen sc1
  buffer_load_dword v38, v7, s[40:43], s56 offen offset:2048 sc1
  buffer_load_dword v39, v7, s[40:43], s57 offen sc1
  s_waitcnt vmcnt(0)
  v_max3_u32 v112, v37, v38, v39
  v_cmp_eq_u32 vcc, -1, v112
  s_cbranch_vccz POLLD_26
  s_sub_u32 s62, s62, 1
  s_cbranch_scc1 POLLD_26
  s_sleep 4
  s_branch POLL_25
POLLD_26:
  v_lshlrev_b32 v224, 16, v36
  v_and_b32 v225, 0xffff0000, v36
  v_lshlrev_b32 v226, 16, v37
  v_and_b32 v227, 0xffff0000, v37
  v_lshlrev_b32 v228, 16, v38
  v_and_b32 v229, 0xffff0000, v38
  v_lshlrev_b32 v230, 16, v39
  v_and_b32 v231, 0xffff0000, v39
  v_add_f32 v230, 1.0, v230
  v_add_f32 v231, 1.0, v231
  v_cvt_pk_bf16_f32 v112, v230, v231
  v_lshlrev_b32 v230, 16, v112
  v_and_b32 v231, 0xffff0000, v112
  s_branch L_H3
L_H1:
  s_cmp_eq_u32 s68, 2
  s_cbranch_scc0 L_H2
  s_mov_b32 s52, s4
  s_mov_b32 s53, s5
  s_mov_b32 s54, 2048
  s_mov_b32 s55, 0x00020000
  v_and_b32 v4, 31, v1
  v_lshlrev_b32 v4, 1, v4
  v_lshl_add_u32 v124, v13, 10, v4
  s_lshl_b32 s56, s70, 6
  buffer_load_ushort v125, v124, s[52:55], s56 offen
  v_lshl_add_u32 v7, v13, 6, v4
  s_lshl_b32 s56, s70, 7
  s_add_u32 s56, s56, 20480
  s_add_u32 s57, s56, 6144
  s_mov_b32 s62, 400000
POLL_27:
  buffer_load_ushort v126, v7, s[40:43], s56 offen sc1
  buffer_load_ushort v127, v7, s[40:43], s57 offen sc1
  s_waitcnt vmcnt(0)
  v_max_u32 v112, v126, v127
  v_cmp_eq_u32 vcc, 0xffff, v112
  s_cbranch_vccz POLLD_28
  s_sub_u32 s62, s62, 1
  s_cbranch_scc1 POLLD_28
  s_sleep 4
  s_branch POLL_27
POLLD_28:
  v_lshlrev_b32 v125, 16, v125
  v_lshlrev_b32 v126, 16, v126
  v_lshlrev_b32 v127, 16, v127
  s_branch L_H3
L_H2:
  v_lshrrev_b32 v12, 2, v5
  v_lshlrev_b32 v12, 3, v12
  v_lshl_add_u32 v12, v6, 1, v12
  v_lshlrev_b32 v12, 7, v12
  v_and_b32 v4, 3, v1
  v_lshl_add_u32 v12, v4, 3, v12
  s_lshl_b32 s56, s82, 14
  s_add_u32 s56, s56, 32768
  v_add_u32 v12, s56, v12
  ds_read_b64_tr_b16 v[160:161], v12 offset:0
  ds_read_b64_tr_b16 v[162:163], v12 offset:128
  ds_read_b64_tr_b16 v[164:165], v12 offset:32
  ds_read_b64_tr_b16 v[166:167], v12 offset:160
  ds_read_b64_tr_b16 v[168:169], v12 offset:64
  ds_read_b64_tr_b16 v[170:171], v12 offset:192
  ds_read_b64_tr_b16 v[172:173], v12 offset:96
  ds_read_b64_tr_b16 v[174:175], v12 offset:224
  ds_read_b64_tr_b16 v[176:177], v12 offset:4096
  ds_read_b64_tr_b16 v[178:179], v12 offset:4224
  ds_read_b64_tr_b16 v[180:181], v12 offset:4128
  ds_read_b64_tr_b16 v[182:183], v12 offset:4256
  ds_read_b64_tr_b16 v[184:185], v12 offset:4160
  ds_read_b64_tr_b16 v[186:187], v12 offset:4288
  ds_read_b64_tr_b16 v[188:189], v12 offset:4192
  ds_read_b64_tr_b16 v[190:191], v12 offset:4320
  ds_read_b64_tr_b16 v[192:193], v12 offset:8192
  ds_read_b64_tr_b16 v[194:195], v12 offset:8320
  ds_read_b64_tr_b16 v[196:197], v12 offset:8224
  ds_read_b64_tr_b16 v[198:199], v12 offset:8352
  ds_read_b64_tr_b16 v[200:201], v12 offset:8256
  ds_read_b64_tr_b16 v[202:203], v12 offset:8384
  ds_read_b64_tr_b16 v[204:205], v12 offset:8288
  ds_read_b64_tr_b16 v[206:207], v12 offset:8416
  ds_read_b64_tr_b16 v[208:209], v12 offset:12288
  ds_read_b64_tr_b16 v[210:211], v12 offset:12416
  ds_read_b64_tr_b16 v[212:213], v12 offset:12320
  ds_read_b64_tr_b16 v[214:215], v12 offset:12448
  ds_read_b64_tr_b16 v[216:217], v12 offset:12352
  ds_read_b64_tr_b16 v[218:219], v12 offset:12480
  ds_read_b64_tr_b16 v[220:221], v12 offset:12384
  ds_read_b64_tr_b16 v[222:223], v12 offset:12512
L_H3:
  v_lshlrev_b32 v241, 3, v1
  s_lshl_b32 s56, s82, 9
  s_add_u32 s56, s56, 114688
  v_add_u32 v242, s56, v241
  s_lshl_b32 s56, s82, 6
  s_add_u32 s56, s56, 137216
  v_and_b32 v4, 7, v1
  v_lshlrev_b32 v4, 3, v4
  v_add_u32 v243, s56, v4
  v_add_u32 v240, v5, v13
  v_and_b32 v240, 15, v240
  v_lshlrev_b32 v240, 3, v240
  v_and_b32 v246, 31, v1
  v_lshlrev_b32 v232, 4, v246
  v_lshl_add_u32 v232, v13, 11, v232
  v_add_u32 v233, 4096, v232
  v_add_u32 v234, 8192, v232
  v_add_u32 v235, 12288, v232
  v_add_u32 v236, 16384, v232
  v_add_u32 v237, 20480, v232
  v_add_u32 v238, 24576, v232
  v_add_u32 v239, 28672, v232
  s_lshl_b32 s56, s3, 8
  s_add_u32 s56, s56, 131072
  v_lshlrev_b32 v244, 3, v246
  v_lshl_add_u32 v244, v13, 2, v244
  v_add_u32 v244, s56, v244
  v_lshlrev_b32 v120, 4, v6
  v_add_u32 v120, s56, v120
  v_lshlrev_b32 v246, 2, v1
  v_add_u32 v245, 133120, v246
  s_lshl_b32 s56, s76, 4
  s_add_u32 s56, s56, s77
  s_lshl_b32 s56, s56, 11
  s_lshl_b32 s57, s82, 9
  s_add_u32 s57, s57, 90112
  s_add_u32 s83, s56, s57
  s_lshl_b32 s58, s71, 3
  s_add_u32 s58, s58, s30
  s_lshl_b32 s56, s58, 15
  s_add_u32 s85, s56, s57
  s_lshl_b32 s57, s82, 7
  s_add_u32 s57, s57, 81920
  s_lshl_b32 s56, s58, 9
  s_add_u32 s86, s56, s57
  s_lshl_b32 s56, s76, 9
  s_add_u32 s84, s56, s57
  s_lshl_b32 s56, s77, 3
  s_add_u32 s84, s84, s56
  s_lshl_b32 s87, s58, 11
  s_lshl_b32 s56, s70, 8
  s_add_u32 s87, s87, s56
  s_add_u32 s87, s87, 45056
  s_lshl_b32 s92, s71, 14
  s_lshl_b32 s56, s82, 9
  s_add_u32 s92, s92, s56
  s_add_u32 s92, s92, 45056
  s_mul_i32 s93, s71, 56
  s_add_u32 s93, s93, s70
  s_lshl_b32 s93, s93, 7
  s_add_u32 s93, s93, 28672
  s_lshl_b32 s56, s82, 3
  s_add_u32 s56, s56, 137472
  v_mov_b32 v250, s56
  v_and_b32 v251, 3, v1
  v_lshlrev_b32 v251, 3, v251
  v_add_u32 v251, 137472, v251
  v_lshlrev_b32 v252, 1, v1
  s_waitcnt lgkmcnt(0)
  s_barrier
  ds_read_b64 v[64:65], v243
  ds_read_b64 v[48:49], v242 offset:0
  ds_read_b64 v[50:51], v242 offset:2048
  ds_read_b64 v[52:53], v242 offset:4096
  ds_read_b64 v[54:55], v242 offset:6144
  ds_read_b64 v[56:57], v242 offset:8192
  ds_read_b64 v[58:59], v242 offset:10240
  ds_read_b64 v[60:61], v242 offset:12288
  ds_read_b64 v[62:63], v242 offset:14336
  s_waitcnt lgkmcnt(8)
  v_mov_b32 v112, v64
  s_nop 1
  v_max_f32_dpp v112, v112, v112 row_ror:4 row_mask:0xf bank_mask:0xf
  s_nop 1
  v_max_f32_dpp v112, v112, v112 row_ror:2 row_mask:0xf bank_mask:0xf
  s_nop 1
  v_max_f32_dpp v112, v112, v112 row_ror:1 row_mask:0xf bank_mask:0xf
  v_sub_f32 v64, v64, v112
  v_mul_f32 v64, s65, v64
  v_exp_f32 v64, v64
  s_waitcnt lgkmcnt(0)
  v_mul_f32 v113, v64, v65
  v_mul_f32_dpp v114, v64, v48 row_newbcast:0 row_mask:0xf bank_mask:0xf
  v_mul_f32_dpp v115, v64, v49 row_newbcast:0 row_mask:0xf bank_mask:0xf
  v_fmac_f32_dpp v114, v64, v50 row_newbcast:1 row_mask:0xf bank_mask:0xf
  v_fmac_f32_dpp v115, v64, v51 row_newbcast:1 row_mask:0xf bank_mask:0xf
  v_add_f32_dpp v113, v113, v113 row_ror:4 row_mask:0xf bank_mask:0xf
  v_fmac_f32_dpp v114, v64, v52 row_newbcast:2 row_mask:0xf bank_mask:0xf
  v_fmac_f32_dpp v115, v64, v53 row_newbcast:2 row_mask:0xf bank_mask:0xf
  v_add_f32_dpp v113, v113, v113 row_ror:2 row_mask:0xf bank_mask:0xf
  v_fmac_f32_dpp v114, v64, v54 row_newbcast:3 row_mask:0xf bank_mask:0xf
  v_fmac_f32_dpp v115, v64, v55 row_newbcast:3 row_mask:0xf bank_mask:0xf
  v_add_f32_dpp v113, v113, v113 row_ror:1 row_mask:0xf bank_mask:0xf
  v_fmac_f32_dpp v114, v64, v56 row_newbcast:4 row_mask:0xf bank_mask:0xf
  v_fmac_f32_dpp v115, v64, v57 row_newbcast:4 row_mask:0xf bank_mask:0xf
  v_fmac_f32_dpp v114, v64, v58 row_newbcast:5 row_mask:0xf bank_mask:0xf
  v_fmac_f32_dpp v115, v64, v59 row_newbcast:5 row_mask:0xf bank_mask:0xf
  v_fmac_f32_dpp v114, v64, v60 row_newbcast:6 row_mask:0xf bank_mask:0xf
  v_fmac_f32_dpp v115, v64, v61 row_newbcast:6 row_mask:0xf bank_mask:0xf
  v_fmac_f32_dpp v114, v64, v62 row_newbcast:7 row_mask:0xf bank_mask:0xf
  v_fmac_f32_dpp v115, v64, v63 row_newbcast:7 row_mask:0xf bank_mask:0xf
  buffer_store_dwordx2 v[114:115], v241, s[40:43], s83 offen sc1
  s_mov_b64 exec, 1
  buffer_store_dwordx2 v[112:113], v15, s[40:43], s84 offen sc1
  s_mov_b64 exec, -1
  s_waitcnt vmcnt(0)
  s_cmp_eq_u32 s68, 0
  s_cbranch_scc0 L_T4
  s_mov_b32 s62, 400000
POLL_29:
  buffer_load_dwordx2 v[80:81], v240, s[40:43], s86 offen sc1
  buffer_load_dwordx4 v[48:51], v232, s[40:43], s85 offen sc1
  buffer_load_dwordx4 v[52:55], v233, s[40:43], s85 offen sc1
  buffer_load_dwordx4 v[56:59], v234, s[40:43], s85 offen sc1
  buffer_load_dwordx4 v[60:63], v235, s[40:43], s85 offen sc1
  buffer_load_dwordx4 v[64:67], v236, s[40:43], s85 offen sc1
  buffer_load_dwordx4 v[68:71], v237, s[40:43], s85 offen sc1
  buffer_load_dwordx4 v[72:75], v238, s[40:43], s85 offen sc1
  buffer_load_dwordx4 v[76:79], v239, s[40:43], s85 offen sc1
  s_waitcnt vmcnt(0)
  v_max3_u32 v112, v48, v49, v50
  v_max3_u32 v112, v112, v51, v52
  v_max3_u32 v112, v112, v53, v54
  v_max3_u32 v112, v112, v55, v56
  v_max3_u32 v112, v112, v57, v58
  v_max3_u32 v112, v112, v59, v60
  v_max3_u32 v112, v112, v61, v62
  v_max3_u32 v112, v112, v63, v64
  v_max3_u32 v112, v112, v65, v66
  v_max3_u32 v112, v112, v67, v68
  v_max3_u32 v112, v112, v69, v70
  v_max3_u32 v112, v112, v71, v72
  v_max3_u32 v112, v112, v73, v74
  v_max3_u32 v112, v112, v75, v76
  v_max3_u32 v112, v112, v77, v78
  v_max3_u32 v112, v112, v79, v80
  v_max_u32 v112, v112, v81
  v_cmp_eq_u32 vcc, -1, v112
  s_cbranch_vccz POLLD_30
  s_sub_u32 s62, s62, 1
  s_cbranch_scc1 POLLD_30
  s_sleep 2
  s_branch POLL_29
POLLD_30:
  v_mov_b32 v112, v80
  s_nop 1
  v_max_f32_dpp v112, v112, v112 row_ror:8 row_mask:0xf bank_mask:0xf
  s_nop 1
  v_max_f32_dpp v112, v112, v112 row_ror:4 row_mask:0xf bank_mask:0xf
  s_nop 1
  v_max_f32_dpp v112, v112, v112 row_ror:2 row_mask:0xf bank_mask:0xf
  s_nop 1
  v_max_f32_dpp v112, v112, v112 row_ror:1 row_mask:0xf bank_mask:0xf
  v_sub_f32 v82, v80, v112
  v_mul_f32 v82, s65, v82
  v_exp_f32 v82, v82
  s_nop 0
  v_mul_f32 v113, v82, v81
  v_mul_f32_dpp v36, v82, v48 row_newbcast:0 row_mask:0xf bank_mask:0xf
  v_mul_f32_dpp v37, v82, v49 row_newbcast:0 row_mask:0xf bank_mask:0xf
  v_mul_f32_dpp v38, v82, v50 row_newbcast:0 row_mask:0xf bank_mask:0xf
  v_mul_f32_dpp v39, v82, v51 row_newbcast:0 row_mask:0xf bank_mask:0xf
  v_add_f32_dpp v113, v113, v113 row_ror:8 row_mask:0xf bank_mask:0xf
  v_fmac_f32_dpp v36, v82, v52 row_newbcast:2 row_mask:0xf bank_mask:0xf
  v_fmac_f32_dpp v37, v82, v53 row_newbcast:2 row_mask:0xf bank_mask:0xf
  v_fmac_f32_dpp v38, v82, v54 row_newbcast:2 row_mask:0xf bank_mask:0xf
  v_fmac_f32_dpp v39, v82, v55 row_newbcast:2 row_mask:0xf bank_mask:0xf
  v_add_f32_dpp v113, v113, v113 row_ror:4 row_mask:0xf bank_mask:0xf
  v_fmac_f32_dpp v36, v82, v56 row_newbcast:4 row_mask:0xf bank_mask:0xf
  v_fmac_f32_dpp v37, v82, v57 row_newbcast:4 row_mask:0xf bank_mask:0xf
  v_fmac_f32_dpp v38, v82, v58 row_newbcast:4 row_mask:0xf bank_mask:0xf
  v_fmac_f32_dpp v39, v82, v59 row_newbcast:4 row_mask:0xf bank_mask:0xf
  v_add_f32_dpp v113, v113, v113 row_ror:2 row_mask:0xf bank_mask:0xf
  v_fmac_f32_dpp v36, v82, v60 row_newbcast:6 row_mask:0xf bank_mask:0xf
  v_fmac_f32_dpp v37, v82, v61 row_newbcast:6 row_mask:0xf bank_mask:0xf
  v_fmac_f32_dpp v38, v82, v62 row_newbcast:6 row_mask:0xf bank_mask:0xf
  v_fmac_f32_dpp v39, v82, v63 row_newbcast:6 row_mask:0xf bank_mask:0xf
  v_add_f32_dpp v113, v113, v113 row_ror:1 row_mask:0xf bank_mask:0xf
  v_fmac_f32_dpp v36, v82, v64 row_newbcast:8 row_mask:0xf bank_mask:0xf
  v_fmac_f32_dpp v37, v82, v65 row_newbcast:8 row_mask:0xf bank_mask:0xf
  v_fmac_f32_dpp v38, v82, v66 row_newbcast:8 row_mask:0xf bank_mask:0xf
  v_fmac_f32_dpp v39, v82, v67 row_newbcast:8 row_mask:0xf bank_mask:0xf
  v_fmac_f32_dpp v36, v82, v68 row_newbcast:10 row_mask:0xf bank_mask:0xf
  v_fmac_f32_dpp v37, v82, v69 row_newbcast:10 row_mask:0xf bank_mask:0xf
  v_fmac_f32_dpp v38, v82, v70 row_newbcast:10 row_mask:0xf bank_mask:0xf
  v_fmac_f32_dpp v39, v82, v71 row_newbcast:10 row_mask:0xf bank_mask:0xf
  v_fmac_f32_dpp v36, v82, v72 row_newbcast:12 row_mask:0xf bank_mask:0xf
  v_fmac_f32_dpp v37, v82, v73 row_newbcast:12 row_mask:0xf bank_mask:0xf
  v_fmac_f32_dpp v38, v82, v74 row_newbcast:12 row_mask:0xf bank_mask:0xf
  v_fmac_f32_dpp v39, v82, v75 row_newbcast:12 row_mask:0xf bank_mask:0xf
  v_fmac_f32_dpp v36, v82, v76 row_newbcast:14 row_mask:0xf bank_mask:0xf
  v_fmac_f32_dpp v37, v82, v77 row_newbcast:14 row_mask:0xf bank_mask:0xf
  v_fmac_f32_dpp v38, v82, v78 row_newbcast:14 row_mask:0xf bank_mask:0xf
  v_fmac_f32_dpp v39, v82, v79 row_newbcast:14 row_mask:0xf bank_mask:0xf
  v_rcp_f32 v116, v113
  s_nop 0
  v_permlane32_swap_b32 v36, v38
  v_permlane32_swap_b32 v37, v39
  v_add_f32 v114, v36, v38
  v_add_f32 v115, v37, v39
  v_mul_f32 v117, v114, v116
  v_fma_f32 v114, -v117, v113, v114
  v_fma_f32 v114, v114, v116, v117
  v_mul_f32 v118, v115, v116
  v_fma_f32 v115, -v118, v113, v115
  v_fma_f32 v115, v115, v116, v118
  v_cvt_pk_bf16_f32 v114, v114, v115
  ds_write_b32 v244, v114
  s_waitcnt lgkmcnt(0)
  ds_read_b128 v[84:87], v120 offset:0
  ds_read_b128 v[88:91], v120 offset:64
  ds_read_b128 v[92:95], v120 offset:128
  ds_read_b128 v[96:99], v120 offset:192
  s_waitcnt lgkmcnt(3)
  v_mfma_f32_16x16x32_bf16 v[48:51], v[160:163], v[84:87], 0
  v_mfma_f32_16x16x32_bf16 v[52:55], v[164:167], v[84:87], 0
  v_mfma_f32_16x16x32_bf16 v[56:59], v[168:171], v[84:87], 0
  v_mfma_f32_16x16x32_bf16 v[60:63], v[172:175], v[84:87], 0
  s_waitcnt lgkmcnt(2)
  v_mfma_f32_16x16x32_bf16 v[48:51], v[176:179], v[88:91], v[48:51]
  v_mfma_f32_16x16x32_bf16 v[52:55], v[180:183], v[88:91], v[52:55]
  v_mfma_f32_16x16x32_bf16 v[56:59], v[184:187], v[88:91], v[56:59]
  v_mfma_f32_16x16x32_bf16 v[60:63], v[188:191], v[88:91], v[60:63]
  s_waitcnt lgkmcnt(1)
  v_mfma_f32_16x16x32_bf16 v[48:51], v[192:195], v[92:95], v[48:51]
  v_mfma_f32_16x16x32_bf16 v[52:55], v[196:199], v[92:95], v[52:55]
  v_mfma_f32_16x16x32_bf16 v[56:59], v[200:203], v[92:95], v[56:59]
  v_mfma_f32_16x16x32_bf16 v[60:63], v[204:207], v[92:95], v[60:63]
  s_waitcnt lgkmcnt(0)
  v_mfma_f32_16x16x32_bf16 v[48:51], v[208:211], v[96:99], v[48:51]
  v_mfma_f32_16x16x32_bf16 v[52:55], v[212:215], v[96:99], v[52:55]
  v_mfma_f32_16x16x32_bf16 v[56:59], v[216:219], v[96:99], v[56:59]
  v_mfma_f32_16x16x32_bf16 v[60:63], v[220:223], v[96:99], v[60:63]
  s_mov_b32 exec_lo, 0x00010001
  s_mov_b32 exec_hi, 0x00010001
  s_nop 5
  ds_write_b128 v121, v[48:51] offset:0
  ds_write_b128 v121, v[52:55] offset:64
  ds_write_b128 v121, v[56:59] offset:128
  ds_write_b128 v121, v[60:63] offset:192
  s_mov_b64 exec, -1
  s_waitcnt lgkmcnt(0)
  s_barrier
  s_cmp_eq_u32 s3, 7
  s_cbranch_scc0 L_END
  ds_read_b32 v84, v245 offset:2048
  ds_read_b32 v85, v245 offset:2560
  ds_read_b32 v86, v245 offset:3072
  ds_read_b32 v87, v245 offset:3584
  s_waitcnt lgkmcnt(0)
  v_add_f32 v84, v84, v85
  v_add_f32 v86, v86, v87
  v_add_f32 v84, v84, v86
  buffer_store_dword v84, v246, s[40:43], s87 offen sc1
  s_branch L_END
L_T4:
  s_cmp_eq_u32 s68, 2
  s_cbranch_scc1 L_T5
L_T4C:
  s_lshl_b32 s59, s70, 6
  s_mov_b32 s44, s16
  s_mov_b32 s45, s17
  s_mov_b32 s46, 1835008
  s_mov_b32 s47, 0x00020000
  v_lshrrev_b32 v4, 2, v1
  v_mul_u32_u24 v4, 3584, v4
  v_and_b32 v7, 3, v1
  v_lshl_add_u32 v4, v7, 4, v4
  s_mul_i32 s56, s82, 458752
  s_add_u32 s56, s56, s59
  s_mul_i32 s58, s82, 8192
  s_add_u32 s58, s58, 0
  s_mov_b32 m0, s58
  s_add_u32 s58, s58, 1024
  buffer_load_dwordx4 v4, s[44:47], s56 offen  lds
  s_add_u32 s56, s56, 57344
  s_mov_b32 m0, s58
  s_add_u32 s58, s58, 1024
  buffer_load_dwordx4 v4, s[44:47], s56 offen  lds
  s_add_u32 s56, s56, 57344
  s_mov_b32 m0, s58
  s_add_u32 s58, s58, 1024
  buffer_load_dwordx4 v4, s[44:47], s56 offen  lds
  s_add_u32 s56, s56, 57344
  s_mov_b32 m0, s58
  s_add_u32 s58, s58, 1024
  buffer_load_dwordx4 v4, s[44:47], s56 offen  lds
  s_add_u32 s56, s56, 57344
  s_mov_b32 m0, s58
  s_add_u32 s58, s58, 1024
  buffer_load_dwordx4 v4, s[44:47], s56 offen  lds
  s_add_u32 s56, s56, 57344
  s_mov_b32 m0, s58
  s_add_u32 s58, s58, 1024
  buffer_load_dwordx4 v4, s[44:47], s56 offen  lds
  s_add_u32 s56, s56, 57344
  s_mov_b32 m0, s58
  s_add_u32 s58, s58, 1024
  buffer_load_dwordx4 v4, s[44:47], s56 offen  lds
  s_add_u32 s56, s56, 57344
  s_mov_b32 m0, s58
  s_add_u32 s58, s58, 1024
  buffer_load_dwordx4 v4, s[44:47], s56 offen  lds
  v_lshrrev_b32 v12, 2, v5
  v_lshl_add_u32 v12, v6, 3, v12
  v_mul_u32_u24 v12, 64, v12
  v_and_b32 v4, 3, v1
  v_lshl_add_u32 v12, v4, 3, v12
  s_mul_i32 s56, s82, 8192
  s_add_u32 s56, s56, 0
  v_add_u32 v12, s56, v12
  s_waitcnt vmcnt(0)
  ds_read_b64_tr_b16 v[160:161], v12 offset:0
  ds_read_b64_tr_b16 v[162:163], v12 offset:256
  ds_read_b64_tr_b16 v[164:165], v12 offset:32
  ds_read_b64_tr_b16 v[166:167], v12 offset:288
  ds_read_b64_tr_b16 v[168:169], v12 offset:2048
  ds_read_b64_tr_b16 v[170:171], v12 offset:2304
  ds_read_b64_tr_b16 v[172:173], v12 offset:2080
  ds_read_b64_tr_b16 v[174:175], v12 offset:2336
  ds_read_b64_tr_b16 v[176:177], v12 offset:4096
  ds_read_b64_tr_b16 v[178:179], v12 offset:4352
  ds_read_b64_tr_b16 v[180:181], v12 offset:4128
  ds_read_b64_tr_b16 v[182:183], v12 offset:4384
  ds_read_b64_tr_b16 v[184:185], v12 offset:6144
  ds_read_b64_tr_b16 v[186:187], v12 offset:6400
  ds_read_b64_tr_b16 v[188:189], v12 offset:6176
  ds_read_b64_tr_b16 v[190:191], v12 offset:6432
  s_mov_b32 s62, 400000
POLL_31:
  buffer_load_dwordx4 v[128:131], v232, s[40:43], s92 offen sc1
  buffer_load_dwordx4 v[132:135], v233, s[40:43], s92 offen sc1
  buffer_load_dwordx4 v[136:139], v234, s[40:43], s92 offen sc1
  buffer_load_dwordx4 v[140:143], v235, s[40:43], s92 offen sc1
  s_waitcnt vmcnt(0)
  v_max3_u32 v112, v128, v129, v130
  v_max3_u32 v112, v112, v131, v132
  v_max3_u32 v112, v112, v133, v134
  v_max3_u32 v112, v112, v135, v136
  v_max3_u32 v112, v112, v137, v138
  v_max3_u32 v112, v112, v139, v140
  v_max3_u32 v112, v112, v141, v142
  v_max_u32 v112, v112, v143
  v_cmp_eq_u32 vcc, -1, v112
  s_cbranch_vccz POLLD_32
  s_sub_u32 s62, s62, 1
  s_cbranch_scc1 POLLD_32
  s_sleep 2
  s_branch POLL_31
POLLD_32:
  v_pk_add_f32 v[36:37], v[128:129], v[132:133]
  v_pk_add_f32 v[38:39], v[130:131], v[134:135]
  v_pk_add_f32 v[36:37], v[36:37], v[136:137]
  v_pk_add_f32 v[38:39], v[38:39], v[138:139]
  v_pk_add_f32 v[36:37], v[36:37], v[140:141]
  v_pk_add_f32 v[38:39], v[38:39], v[142:143]
  s_nop 1
  v_permlane32_swap_b32 v36, v38
  v_permlane32_swap_b32 v37, v39
  v_pk_add_f32 v[36:37], v[36:37], v[38:39]
  v_cvt_pk_bf16_f32 v112, v36, v37
  v_lshlrev_b32 v36, 16, v112
  v_and_b32 v37, 0xffff0000, v112
  v_pk_mul_f32 v[36:37], v[36:37], v[226:227]
  v_cvt_pk_bf16_f32 v112, v36, v37
  v_lshlrev_b32 v36, 16, v112
  v_and_b32 v37, 0xffff0000, v112
  v_pk_add_f32 v[36:37], v[36:37], v[224:225]
  v_cvt_pk_bf16_f32 v112, v36, v37
  v_lshlrev_b32 v36, 16, v112
  v_and_b32 v37, 0xffff0000, v112
  v_add_f32 v112, v36, v37
  v_mul_f32 v113, v36, v36
  v_fmac_f32 v113, v37, v37
  s_nop 0
  s_nop 0
  v_add_f32_dpp v112, v112, v112 row_ror:8 row_mask:0xf bank_mask:0xf
  v_add_f32_dpp v113, v113, v113 row_ror:8 row_mask:0xf bank_mask:0xf
  s_nop 0
  v_add_f32_dpp v112, v112, v112 row_ror:4 row_mask:0xf bank_mask:0xf
  v_add_f32_dpp v113, v113, v113 row_ror:4 row_mask:0xf bank_mask:0xf
  s_nop 0
  v_add_f32_dpp v112, v112, v112 row_ror:2 row_mask:0xf bank_mask:0xf
  v_add_f32_dpp v113, v113, v113 row_ror:2 row_mask:0xf bank_mask:0xf
  s_nop 0
  v_add_f32_dpp v112, v112, v112 row_ror:1 row_mask:0xf bank_mask:0xf
  v_add_f32_dpp v113, v113, v113 row_ror:1 row_mask:0xf bank_mask:0xf
  v_mov_b32 v114, v112
  v_mov_b32 v115, v113
  s_nop 1
  v_permlane16_swap_b32 v112, v114
  v_permlane16_swap_b32 v113, v115
  v_add_f32 v112, v112, v114
  v_add_f32 v113, v113, v115
  v_mov_b32 v114, v112
  v_mov_b32 v115, v113
  s_nop 1
  v_permlane32_swap_b32 v112, v114
  v_permlane32_swap_b32 v113, v115
  v_add_f32 v112, v112, v114
  v_add_f32 v113, v113, v115
  s_mov_b64 exec, 1
  ds_write_b64 v250, v[112:113]
  s_mov_b64 exec, -1
  s_waitcnt lgkmcnt(0)
  s_barrier
  ds_read_b64 v[112:113], v251
  s_waitcnt lgkmcnt(0)
  s_nop 0
  v_add_f32_dpp v112, v112, v112 row_ror:2 row_mask:0xf bank_mask:0xf
  v_add_f32_dpp v113, v113, v113 row_ror:2 row_mask:0xf bank_mask:0xf
  s_nop 0
  v_add_f32_dpp v112, v112, v112 row_ror:1 row_mask:0xf bank_mask:0xf
  v_add_f32_dpp v113, v113, v113 row_ror:1 row_mask:0xf bank_mask:0xf
  v_mul_f32 v112, 989855744, v112
  v_mul_f32 v113, 989855744, v113
  v_fma_f32 v113, -v112, v112, v113
  v_max_f32 v113, 0, v113
  v_cvt_pk_bf16_f32 v114, v112, v113
  v_lshlrev_b32 v112, 16, v114
  v_and_b32 v113, 0xffff0000, v114
  v_add_f32 v113, 925353388, v113
  v_cvt_pk_bf16_f32 v113, v113, v113
  v_lshlrev_b32 v113, 16, v113
  v_sqrt_f32 v113, v113
  v_sub_f32 v36, v36, v112
  v_sub_f32 v37, v37, v112
  v_cvt_pk_bf16_f32 v113, v113, v113
  v_lshlrev_b32 v113, 16, v113
  v_rcp_f32 v116, v113
  v_cvt_pk_bf16_f32 v114, v36, v37
  v_lshlrev_b32 v36, 16, v114
  v_and_b32 v37, 0xffff0000, v114
  v_mul_f32 v114, v36, v116
  v_fma_f32 v36, -v114, v113, v36
  v_fma_f32 v36, v36, v116, v114
  v_mul_f32 v115, v37, v116
  v_fma_f32 v37, -v115, v113, v37
  v_fma_f32 v37, v37, v116, v115
  v_cvt_pk_bf16_f32 v114, v36, v37
  v_lshlrev_b32 v36, 16, v114
  v_and_b32 v37, 0xffff0000, v114
  v_pk_mul_f32 v[36:37], v[36:37], v[230:231]
  v_cvt_pk_bf16_f32 v112, v36, v37
  v_lshlrev_b32 v36, 16, v112
  v_and_b32 v37, 0xffff0000, v112
  v_pk_add_f32 v[36:37], v[36:37], v[228:229]
  v_cvt_pk_bf16_f32 v36, v36, v37
  ds_write_b32 v244, v36
  s_waitcnt lgkmcnt(0)
  ds_read_b128 v[84:87], v120 offset:0
  ds_read_b128 v[88:91], v120 offset:64
  ds_read_b128 v[92:95], v120 offset:128
  ds_read_b128 v[96:99], v120 offset:192
  s_waitcnt lgkmcnt(3)
  v_mfma_f32_16x16x32_bf16 v[100:103], v[160:163], v[84:87], 0
  v_mfma_f32_16x16x32_bf16 v[104:107], v[164:167], v[84:87], 0
  s_waitcnt lgkmcnt(2)
  v_mfma_f32_16x16x32_bf16 v[100:103], v[168:171], v[88:91], v[100:103]
  v_mfma_f32_16x16x32_bf16 v[104:107], v[172:175], v[88:91], v[104:107]
  s_waitcnt lgkmcnt(1)
  v_mfma_f32_16x16x32_bf16 v[100:103], v[176:179], v[92:95], v[100:103]
  v_mfma_f32_16x16x32_bf16 v[104:107], v[180:183], v[92:95], v[104:107]
  s_waitcnt lgkmcnt(0)
  v_mfma_f32_16x16x32_bf16 v[100:103], v[184:187], v[96:99], v[100:103]
  v_mfma_f32_16x16x32_bf16 v[104:107], v[188:191], v[96:99], v[104:107]
  s_mov_b32 exec_lo, 0x00010001
  s_mov_b32 exec_hi, 0x00010001
  s_nop 5
  ds_write_b128 v121, v[100:103] offset:0
  ds_write_b128 v121, v[104:107] offset:64
  s_mov_b64 exec, -1
  s_waitcnt lgkmcnt(0)
  s_barrier
  s_cmp_eq_u32 s3, 4
  s_cbranch_scc0 L_END
  ds_read_b32 v84, v245 offset:2048
  ds_read_b32 v85, v245 offset:2560
  ds_read_b32 v86, v245 offset:3072
  ds_read_b32 v87, v245 offset:3584
  s_waitcnt lgkmcnt(0)
  v_add_f32 v84, v84, v85
  v_add_f32 v86, v86, v87
  v_add_f32 v84, v84, v86
  v_cvt_pk_bf16_f32 v84, v84, v84
  v_lshlrev_b32 v84, 16, v84
  v_mul_f32 v112, s65, v84
  v_max_f32 v112, 3271294976, v112
  v_exp_f32 v112, -v112
  s_nop 0
  v_add_f32 v112, 1.0, v112
  v_rcp_f32 v113, v112
  s_nop 0
  v_mul_f32 v114, v84, v113
  v_fma_f32 v84, -v114, v112, v84
  v_fma_f32 v84, v84, v113, v114
  s_nop 1
  v_mov_b32_dpp v85, v84 quad_perm:[1,0,3,2] row_mask:0xf bank_mask:0xf
  v_cvt_pk_bf16_f32 v84, v84, v85
  s_mov_b32 exec_lo, 0x55555555
  s_mov_b32 exec_hi, 0
  buffer_store_dword v84, v252, s[40:43], s93 offen sc1
  s_mov_b64 exec, -1
  s_branch L_END
L_T5:
  s_setprio 0
  s_barrier
  s_lshl_b32 s59, s70, 6
  s_mov_b32 s44, s18
  s_mov_b32 s45, s19
  s_mov_b32 s46, 1835008
  s_mov_b32 s47, 0x00020000
  v_lshrrev_b32 v4, 2, v1
  v_mul_u32_u24 v4, 1024, v4
  v_and_b32 v7, 3, v1
  v_lshl_add_u32 v4, v7, 4, v4
  s_mul_i32 s56, s3, 229376
  s_add_u32 s56, s56, s59
  s_mul_i32 s58, s3, 14336
  s_add_u32 s58, s58, 0
  s_mov_b32 m0, s58
  s_add_u32 s58, s58, 1024
  buffer_load_dwordx4 v4, s[44:47], s56 offen  lds
  s_add_u32 s56, s56, 16384
  s_mov_b32 m0, s58
  s_add_u32 s58, s58, 1024
  buffer_load_dwordx4 v4, s[44:47], s56 offen  lds
  s_add_u32 s56, s56, 16384
  s_mov_b32 m0, s58
  s_add_u32 s58, s58, 1024
  buffer_load_dwordx4 v4, s[44:47], s56 offen  lds
  s_add_u32 s56, s56, 16384
  s_mov_b32 m0, s58
  s_add_u32 s58, s58, 1024
  buffer_load_dwordx4 v4, s[44:47], s56 offen  lds
  s_add_u32 s56, s56, 16384
  s_mov_b32 m0, s58
  s_add_u32 s58, s58, 1024
  buffer_load_dwordx4 v4, s[44:47], s56 offen  lds
  s_add_u32 s56, s56, 16384
  s_mov_b32 m0, s58
  s_add_u32 s58, s58, 1024
  buffer_load_dwordx4 v4, s[44:47], s56 offen  lds
  s_add_u32 s56, s56, 16384
  s_mov_b32 m0, s58
  s_add_u32 s58, s58, 1024
  buffer_load_dwordx4 v4, s[44:47], s56 offen  lds
  s_add_u32 s56, s56, 16384
  s_mov_b32 m0, s58
  s_add_u32 s58, s58, 1024
  buffer_load_dwordx4 v4, s[44:47], s56 offen  lds
  s_add_u32 s56, s56, 16384
  s_mov_b32 m0, s58
  s_add_u32 s58, s58, 1024
  buffer_load_dwordx4 v4, s[44:47], s56 offen  lds
  s_add_u32 s56, s56, 16384
  s_mov_b32 m0, s58
  s_add_u32 s58, s58, 1024
  buffer_load_dwordx4 v4, s[44:47], s56 offen  lds
  s_add_u32 s56, s56, 16384
  s_mov_b32 m0, s58
  s_add_u32 s58, s58, 1024
  buffer_load_dwordx4 v4, s[44:47], s56 offen  lds
  s_add_u32 s56, s56, 16384
  s_mov_b32 m0, s58
  s_add_u32 s58, s58, 1024
  buffer_load_dwordx4 v4, s[44:47], s56 offen  lds
  s_add_u32 s56, s56, 16384
  s_mov_b32 m0, s58
  s_add_u32 s58, s58, 1024
  buffer_load_dwordx4 v4, s[44:47], s56 offen  lds
  s_add_u32 s56, s56, 16384
  s_mov_b32 m0, s58
  s_add_u32 s58, s58, 1024
  buffer_load_dwordx4 v4, s[44:47], s56 offen  lds
  v_lshrrev_b32 v12, 2, v5
  v_lshl_add_u32 v12, v6, 3, v12
  v_mul_u32_u24 v12, 64, v12
  v_and_b32 v4, 3, v1
  v_lshl_add_u32 v12, v4, 3, v12
  s_mul_i32 s56, s3, 14336
  s_add_u32 s56, s56, 0
  v_add_u32 v12, s56, v12
  s_mov_b32 s52, s24
  s_mov_b32 s53, s25
  s_mov_b32 s54, 2048
  s_mov_b32 s55, 0x00020000
  v_lshrrev_b32 v7, 5, v1
  v_and_b32 v4, 31, v1
  v_lshlrev_b32 v232, 2, v4
  v_lshl_add_u32 v232, v7, 14, v232
  v_lshlrev_b32 v4, 1, v4
  v_lshl_add_u32 v124, v7, 10, v4
  v_bfe_u32 v245, v1, 4, 1
  v_lshlrev_b32 v245, 7, v245
  v_lshl_add_u32 v245, v7, 6, v245
  v_lshl_add_u32 v245, v5, 2, v245
  v_add_u32 v245, 133120, v245
  v_lshrrev_b32 v13, 3, v1
  v_min_u32 v13, 6, v13
  v_bfe_u32 v4, v1, 2, 1
  v_mul_u32_u24 v4, 56, v4
  v_add_u32 v13, v13, v4
  v_lshlrev_b32 v13, 7, v13
  v_and_b32 v4, 3, v1
  v_lshl_add_u32 v13, v4, 4, v13
  s_lshl_b32 s56, s3, 10
  s_add_u32 s56, s56, 114688
  v_add_u32 v236, s56, v3
  v_and_b32 v4, 1, v1
  v_lshlrev_b32 v4, 6, v4
  v_lshl_add_u32 v4, v6, 4, v4
  v_add_u32 v237, s56, v4
  s_waitcnt vmcnt(0)
  ds_read_b64_tr_b16 v[144:145], v12 offset:0
  ds_read_b64_tr_b16 v[146:147], v12 offset:256
  ds_read_b64_tr_b16 v[148:149], v12 offset:32
  ds_read_b64_tr_b16 v[150:151], v12 offset:288
  ds_read_b64_tr_b16 v[152:153], v12 offset:2048
  ds_read_b64_tr_b16 v[154:155], v12 offset:2304
  ds_read_b64_tr_b16 v[156:157], v12 offset:2080
  ds_read_b64_tr_b16 v[158:159], v12 offset:2336
  ds_read_b64_tr_b16 v[160:161], v12 offset:4096
  ds_read_b64_tr_b16 v[162:163], v12 offset:4352
  ds_read_b64_tr_b16 v[164:165], v12 offset:4128
  ds_read_b64_tr_b16 v[166:167], v12 offset:4384
  ds_read_b64_tr_b16 v[168:169], v12 offset:6144
  ds_read_b64_tr_b16 v[170:171], v12 offset:6400
  ds_read_b64_tr_b16 v[172:173], v12 offset:6176
  ds_read_b64_tr_b16 v[174:175], v12 offset:6432
  ds_read_b64_tr_b16 v[176:177], v12 offset:8192
  ds_read_b64_tr_b16 v[178:179], v12 offset:8448
  ds_read_b64_tr_b16 v[180:181], v12 offset:8224
  ds_read_b64_tr_b16 v[182:183], v12 offset:8480
  ds_read_b64_tr_b16 v[184:185], v12 offset:10240
  ds_read_b64_tr_b16 v[186:187], v12 offset:10496
  ds_read_b64_tr_b16 v[188:189], v12 offset:10272
  ds_read_b64_tr_b16 v[190:191], v12 offset:10528
  ds_read_b64_tr_b16 v[192:193], v12 offset:12288
  ds_read_b64_tr_b16 v[194:195], v12 offset:12544
  ds_read_b64_tr_b16 v[196:197], v12 offset:12320
  ds_read_b64_tr_b16 v[198:199], v12 offset:12576
  s_cmp_eq_u32 s3, 4
  s_cbranch_scc0 L_T5B
  v_add_u32 v233, 4096, v232
  v_add_u32 v234, 8192, v232
  v_add_u32 v235, 12288, v232
  s_lshl_b32 s57, s70, 7
  s_add_u32 s57, s57, 45056
  s_mov_b32 s62, 400000
POLL_33:
  buffer_load_dword v128, v232, s[40:43], s57 offen offset:0 sc1
  buffer_load_dword v129, v232, s[40:43], s57 offen offset:2048 sc1
  buffer_load_dword v130, v233, s[40:43], s57 offen offset:0 sc1
  buffer_load_dword v131, v233, s[40:43], s57 offen offset:2048 sc1
  buffer_load_dword v132, v234, s[40:43], s57 offen offset:0 sc1
  buffer_load_dword v133, v234, s[40:43], s57 offen offset:2048 sc1
  buffer_load_dword v134, v235, s[40:43], s57 offen offset:0 sc1
  buffer_load_dword v135, v235, s[40:43], s57 offen offset:2048 sc1
  s_waitcnt vmcnt(0)
  v_max3_u32 v112, v128, v129, v130
  v_max3_u32 v112, v112, v131, v132
  v_max3_u32 v112, v112, v133, v134
  v_max_u32 v112, v112, v135
  v_cmp_eq_u32 vcc, -1, v112
  s_cbranch_vccz POLLD_34
  s_sub_u32 s62, s62, 1
  s_cbranch_scc1 POLLD_34
  s_sleep 2
  s_branch POLL_33
POLLD_34:
  v_add_f32 v128, v128, v130
  v_add_f32 v129, v129, v131
  v_add_f32 v128, v128, v132
  v_add_f32 v129, v129, v133
  v_add_f32 v128, v128, v134
  v_add_f32 v129, v129, v135
  v_add_f32 v128, v128, v129
  v_cvt_pk_bf16_f32 v128, v128, v128
  v_lshlrev_b32 v128, 16, v128
  v_mul_f32 v128, v128, v126
  v_cvt_pk_bf16_f32 v128, v128, v128
  v_lshlrev_b32 v128, 16, v128
  v_add_f32 v125, v125, v128
  v_cvt_pk_bf16_f32 v125, v125, v125
  v_lshlrev_b32 v125, 16, v125
L_T5B:
  s_mul_i32 s57, s3, 896
  s_add_u32 s57, s57, 28672
  s_waitcnt lgkmcnt(0)
  s_mov_b32 s62, 400000
POLL_35:
  buffer_load_dwordx4 v[44:47], v13, s[40:43], s57 offen sc1
  s_waitcnt vmcnt(0)
  v_max3_u32 v112, v44, v45, v46
  v_max_u32 v112, v112, v47
  v_cmp_eq_u32 vcc, -1, v112
  s_cbranch_vccz POLLD_36
  s_sub_u32 s62, s62, 1
  s_cbranch_scc1 POLLD_36
  s_sleep 1
  s_branch POLL_35
POLLD_36:
  ds_write_b128 v236, v[44:47]
  s_waitcnt lgkmcnt(0)
  ds_read_b128 v[200:203], v237 offset:0
  ds_read_b128 v[204:207], v237 offset:128
  ds_read_b128 v[208:211], v237 offset:256
  ds_read_b128 v[212:215], v237 offset:384
  ds_read_b128 v[216:219], v237 offset:512
  ds_read_b128 v[220:223], v237 offset:640
  ds_read_b128 v[224:227], v237 offset:768
  s_waitcnt lgkmcnt(6)
  v_mfma_f32_16x16x32_bf16 v[36:39], v[144:147], v[200:203], 0
  v_mfma_f32_16x16x32_bf16 v[40:43], v[148:151], v[200:203], 0
  s_waitcnt lgkmcnt(5)
  v_mfma_f32_16x16x32_bf16 v[36:39], v[152:155], v[204:207], v[36:39]
  v_mfma_f32_16x16x32_bf16 v[40:43], v[156:159], v[204:207], v[40:43]
  s_waitcnt lgkmcnt(4)
  v_mfma_f32_16x16x32_bf16 v[36:39], v[160:163], v[208:211], v[36:39]
  v_mfma_f32_16x16x32_bf16 v[40:43], v[164:167], v[208:211], v[40:43]
  s_waitcnt lgkmcnt(3)
  v_mfma_f32_16x16x32_bf16 v[36:39], v[168:171], v[212:215], v[36:39]
  v_mfma_f32_16x16x32_bf16 v[40:43], v[172:175], v[212:215], v[40:43]
  s_waitcnt lgkmcnt(2)
  v_mfma_f32_16x16x32_bf16 v[36:39], v[176:179], v[216:219], v[36:39]
  v_mfma_f32_16x16x32_bf16 v[40:43], v[180:183], v[216:219], v[40:43]
  s_waitcnt lgkmcnt(1)
  v_mfma_f32_16x16x32_bf16 v[36:39], v[184:187], v[220:223], v[36:39]
  v_mfma_f32_16x16x32_bf16 v[40:43], v[188:191], v[220:223], v[40:43]
  s_waitcnt lgkmcnt(0)
  v_mfma_f32_16x16x32_bf16 v[36:39], v[192:195], v[224:227], v[36:39]
  v_mfma_f32_16x16x32_bf16 v[40:43], v[196:199], v[224:227], v[40:43]
  s_mov_b32 exec_lo, 0x00030003
  s_mov_b32 exec_hi, 0x00030003
  s_nop 5
  ds_write_b128 v121, v[36:39]
  ds_write_b128 v121, v[40:43] offset:128
  s_mov_b64 exec, -1
  s_waitcnt lgkmcnt(0)
  s_barrier
  s_cmp_eq_u32 s3, 4
  s_cbranch_scc0 L_END
  ds_read_b32 v48, v245 offset:0
  ds_read_b32 v49, v245 offset:512
  ds_read_b32 v50, v245 offset:1024
  ds_read_b32 v51, v245 offset:1536
  ds_read_b32 v52, v245 offset:2048
  ds_read_b32 v53, v245 offset:2560
  ds_read_b32 v54, v245 offset:3072
  ds_read_b32 v55, v245 offset:3584
  s_waitcnt lgkmcnt(0)
  v_add_f32 v48, v48, v49
  v_add_f32 v50, v50, v51
  v_add_f32 v52, v52, v53
  v_add_f32 v54, v54, v55
  v_add_f32 v48, v48, v50
  v_add_f32 v52, v52, v54
  v_add_f32 v48, v48, v52
  v_cvt_pk_bf16_f32 v48, v48, v48
  v_lshlrev_b32 v48, 16, v48
  v_mul_f32 v48, v48, v127
  v_cvt_pk_bf16_f32 v48, v48, v48
  v_lshlrev_b32 v48, 16, v48
  v_add_f32 v48, v125, v48
  v_cvt_pk_bf16_f32 v48, v48, v48
  buffer_store_short v48, v124, s[52:55], s59 offen
L_END:
  s_endpgm
.section .rodata,"a"
.p2align 6
.amdhsa_kernel adaLN_cond__gqa_block_cached__dense_activation_silu__decode_kernel
  .amdhsa_next_free_vgpr 256
  .amdhsa_next_free_sgpr 100
  .amdhsa_accum_offset 256
  .amdhsa_group_segment_fixed_size 0
  .amdhsa_kernarg_size 104
  .amdhsa_user_sgpr_count 2
  .amdhsa_user_sgpr_kernarg_segment_ptr 1
  .amdhsa_system_sgpr_workgroup_id_x 1
  .amdhsa_float_denorm_mode_32 3
.end_amdhsa_kernel
```
